```python
import torch

def _softmax(x, axis=-1):
    return torch.softmax(x, dim=axis)
def _gelu(x):
    return torch.nn.functional.gelu(x, approximate="tanh")
def _silu(x):
    return torch.nn.functional.silu(x)
def _sigmoid(x):
    return torch.sigmoid(x)
def _layernorm(x, axis=-1, eps=1e-5):
    m = x.mean(dim=axis, keepdim=True)
    v = x.var(dim=axis, keepdim=True, unbiased=False)
    return (x - m) / torch.sqrt(v + eps)
def _scatter_add(tgt, idx, src, axis=0):
    return tgt.clone().index_add_(axis, idx, src)
def _segment_sum(src, seg, n):
    out = torch.zeros((n,) + src.shape[1:], dtype=src.dtype)
    return out.index_add_(0, seg, src)
def _pad(x, pw):
    flat = tuple(v for pair in reversed(pw) for v in pair)
    return torch.nn.functional.pad(x, flat)

kernel_name = 'gated_mix__mha_block__glu_gated_geglu__prompt'

def setup_inputs():

    _w = (lambda a: (lambda t: t.to(torch.bfloat16) if t.is_floating_point() else t)(torch.as_tensor(a)))
    def _A_setup():
        B, S, D, H = 1, 2048, 512, 32
        return {
            "x": _w((lambda *s: torch.randn(*s, dtype=torch.bfloat16) * 0.05)(B, S, D)),
            "wqkv": _w((lambda *s: torch.randn(*s, dtype=torch.bfloat16) * 0.8)(D, 3 * D)),
            "wo": _w((lambda *s: torch.randn(*s, dtype=torch.bfloat16) * 0.05)(D, D)),
        }
    _A_in = _A_setup()

    def _B_setup():
        B, S, Dm, Df = 1, 2048, 512, 1792
        return {
            "x": _w((lambda *s: torch.randn(*s, dtype=torch.bfloat16) * 0.05)(B, S, Dm)),
            "w_gate": _w((lambda *s: torch.randn(*s, dtype=torch.bfloat16) * 3.2)(Dm, Df) * (Dm ** -0.5)),
            "w_up": _w((lambda *s: torch.randn(*s, dtype=torch.bfloat16) * 3.2)(Dm, Df) * (Dm ** -0.5)),
            "w_down": _w((lambda *s: torch.randn(*s, dtype=torch.bfloat16) * 3.2)(Df, Dm) * (Df ** -0.5)),
        }
    _B_in = _B_setup()

    return {
        "A_x": _A_in["x"],
        "A_wqkv": _A_in["wqkv"],
        "A_wo": _A_in["wo"],
        "B_x": _B_in["x"],
        "B_w_gate": _B_in["w_gate"],
        "B_w_up": _B_in["w_up"],
        "B_w_down": _B_in["w_down"],
        "gate_w": _w((lambda *s: torch.randn(*s, dtype=torch.bfloat16) * 0.05)(512) * 16.0),
    }

def reference(A_x, A_wqkv, A_wo, B_x, B_w_gate, B_w_up, B_w_down, gate_w):
    def _A_ref(x, wqkv, wo):
        B, S, D = x.shape
        H = 32
        Dh = D // H
        qkv = (lambda x, *d: x.permute(*d))((x @ wqkv).reshape(B, S, 3, H, Dh), 2, 0, 3, 1, 4)
        q, k, v = qkv[0], qkv[1], qkv[2]
        scores = torch.einsum("bhqd,bhkd->bhqk", q, k) * (Dh ** -0.5)
        p = _softmax(scores, axis=-1)
        o = torch.einsum("bhqk,bhkd->bhqd", p, v)
        return (lambda x, *d: x.permute(*d))(o, 0, 2, 1, 3).reshape(B, S, D) @ wo

    def _B_ref(x, w_gate, w_up, w_down):
        g = torch.einsum("bsd,df->bsf", x, w_gate)
        u = torch.einsum("bsd,df->bsf", x, w_up)
        h = _gelu(g) * u
        return torch.einsum("bsf,fd->bsd", h, w_down)

    x = A_x
    g = _sigmoid((x * gate_w).sum(-1, keepdims=True))
    a = _A_ref(x, A_wqkv, A_wo)
    b = _B_ref(x, B_w_gate, B_w_up, B_w_down)
    return g * a + (1 - g) * b
```

```asm
; @launch grid=(256,1,1) block=(512,1,1) lds=163840
.amdgcn_target "amdgcn-amd-amdhsa--gfx950"
.text
.globl gated_mix__mha_block__glu_gated_geglu__prompt_kernel
.p2align 8
.type gated_mix__mha_block__glu_gated_geglu__prompt_kernel,@function
gated_mix__mha_block__glu_gated_geglu__prompt_kernel:
    s_cmp_ge_u32 s2, 256
    s_cbranch_scc1 L_exit
    s_load_dwordx16 s[4:19], s[0:1], 0
    s_load_dwordx4 s[20:23], s[0:1], 64
    s_load_dwordx2 s[28:29], s[0:1], 80
    s_getpc_b64 s[84:85]
L_pc:
    v_lshlrev_b32 v61, 7, v0
    v_min_u32 v61, L_exit-L_pc, v61
    global_load_dword v61, v61, s[84:85]
    v_lshrrev_b32 v3, 6, v0
    v_and_b32 v2, 63, v0
    v_readfirstlane_b32 s3, v3
    s_and_b32 s65, s2, 7
    s_lshr_b32 s66, s2, 3
    s_and_b32 s67, s65, 1
    s_lshl_b32 s67, s67, 3
    s_and_b32 s68, s66, 7
    s_add_u32 s60, s67, s68
    s_lshr_b32 s67, s65, 1
    s_lshl_b32 s67, s67, 2
    s_lshr_b32 s68, s66, 3
    s_sub_u32 s68, 3, s68
    s_add_u32 s61, s67, s68
    s_cmp_eq_u32 s68, 3
    s_cselect_b32 s62, 1, 0
    s_lshl_b32 s67, s65, 2
    s_and_b32 s68, s66, 3
    s_add_u32 s63, s67, s68
    s_lshr_b32 s64, s66, 2
    v_lshlrev_b32 v3, 4, v2
    s_mov_b32 s30, 0x2000000
    s_mov_b32 s31, 0x00020000
    s_lshr_b32 s67, s61, 2
    s_sub_u32 s81, s61, s67
    s_add_u32 s81, s81, 16
    s_lshl_b32 s82, s61, 11
    s_lshl_b32 s67, s60, 7
    s_add_u32 s82, s82, s67
    s_add_u32 s82, s82, 21495808
    v_lshrrev_b32 v8, 3, v2
    v_and_b32 v4, 7, v2
    v_bfe_u32 v5, v2, 4, 1
    v_lshlrev_b32 v5, 2, v5
    v_xor_b32 v5, v5, v4
    v_lshlrev_b32 v9, 4, v5
    s_cmp_lt_u32 s3, 4
    s_waitcnt lgkmcnt(0)
    s_mov_b32 s32, s4
    s_mov_b32 s33, s5
    s_mov_b32 s34, 0x200000
    s_mov_b32 s35, 0x00020000
    s_mov_b32 s24, s22
    s_mov_b32 s25, s23
    s_mov_b32 s26, 0x100
    s_mov_b32 s27, 0x00020000
    s_cbranch_scc1 L_compute
L_loader:
    s_setprio 3
    s_sub_u32 s65, s3, 4
    s_lshl_b32 s66, s65, 3
    v_add_u32 v8, s66, v8
    v_lshrrev_b32 v5, 4, v2
    s_and_b32 s66, s65, 1
    s_lshl_b32 s66, s66, 2
    v_add_u32 v5, s66, v5
    v_xor_b32 v5, v5, v4
    v_lshlrev_b32 v5, 4, v5
    v_lshl_add_u32 v12, v8, 10, v5
    s_lshl_b32 s74, s60, 17
    s_lshl_b32 s75, s65, 10
    s_lshl_b32 s90, s61, 1
    s_add_u32 s90, s90, s60
    s_lshl_b32 s90, s61, 2
    s_add_u32 s90, s90, s60
    s_lshl_b32 s91, s90, 1
    s_add_u32 s99, s90, 0
    s_and_b32 s99, s99, 7
    s_lshl_b32 s99, s99, 7
    s_add_u32 s99, s99, s74
    s_add_u32 m0, s75, 0
    s_add_u32 s76, s99, 0
    buffer_load_dwordx4 v12, s[32:35], s76 offen lds
    s_add_u32 m0, s75, 4096
    s_add_u32 s76, s99, 32768
    buffer_load_dwordx4 v12, s[32:35], s76 offen lds
    s_add_u32 m0, s75, 8192
    s_add_u32 s76, s99, 65536
    buffer_load_dwordx4 v12, s[32:35], s76 offen lds
    s_add_u32 m0, s75, 12288
    s_add_u32 s76, s99, 98304
    buffer_load_dwordx4 v12, s[32:35], s76 offen lds
    s_lshl_b32 s66, s65, 8
    s_or_b32 s66, s66, s2
    s_cselect_b32 s83, 0x7ff00000, 0
    s_add_u32 s84, s83, 21626880
    v_mov_b32 v5, 0
    buffer_load_dword v14, v5, s[28:31], s84 offen sc1
    s_mov_b32 s36, s12
    s_mov_b32 s37, s13
    s_mov_b32 s38, 0x1c0000
    s_mov_b32 s39, 0x00020000
    s_mov_b32 s40, s14
    s_mov_b32 s41, s15
    s_mov_b32 s42, 0x1c0000
    s_mov_b32 s43, 0x00020000
    s_mov_b32 s52, s6
    s_mov_b32 s53, s7
    s_mov_b32 s54, 0x180000
    s_mov_b32 s55, 0x00020000
    s_cmp_eq_u32 s62, 1
    s_cselect_b32 s44, s6, s12
    s_cselect_b32 s45, s7, s13
    s_cselect_b32 s46, s54, s38
    s_mov_b32 s47, 0x00020000
    s_cselect_b32 s48, s6, s14
    s_cselect_b32 s49, s7, s15
    s_mov_b32 s50, s46
    s_mov_b32 s51, 0x00020000
    s_movk_i32 s66, 3072
    s_cselect_b32 s66, s66, 3584
    v_mul_u32_u24 v6, 3584, v8
    v_add_u32 v10, v6, v9
    v_mul_u32_u24 v6, 3072, v8
    v_add_u32 v11, v6, v9
    v_mul_u32_u24 v6, s66, v8
    v_add_u32 v13, v6, v9
    s_lshl_b32 s73, s66, 5
    s_lshl_b32 s67, s81, 7
    s_lshr_b32 s68, s61, 2
    s_lshl_b32 s68, s68, 8
    s_add_u32 s68, s68, 2048
    s_add_u32 s69, s68, 128
    s_cmp_eq_u32 s62, 1
    s_cselect_b32 s71, s68, s67
    s_cselect_b32 s69, s69, s67
    s_mov_b32 s94, s71
    s_mov_b32 s95, s69
    s_lshl_b32 s70, s61, 7
    s_add_u32 s92, s91, 0
    s_and_b32 s92, s92, 15
    s_mul_i32 s93, s92, 98304
    s_mul_i32 s92, s92, s73
    s_add_u32 m0, s75, 98304
    s_add_u32 s76, s71, s92
    buffer_load_dwordx4 v13, s[44:47], s76 offen lds
    s_add_u32 m0, s75, 102400
    s_add_u32 s76, s69, s92
    buffer_load_dwordx4 v13, s[48:51], s76 offen lds
    s_add_u32 m0, s75, 106496
    s_add_u32 s76, s70, s93
    buffer_load_dwordx4 v11, s[52:55], s76 offen lds
    s_add_u32 s92, s91, 1
    s_and_b32 s92, s92, 15
    s_mul_i32 s93, s92, 98304
    s_mul_i32 s92, s92, s73
    s_add_u32 m0, s75, 110592
    s_add_u32 s76, s71, s92
    buffer_load_dwordx4 v13, s[44:47], s76 offen lds
    s_add_u32 m0, s75, 114688
    s_add_u32 s76, s69, s92
    buffer_load_dwordx4 v13, s[48:51], s76 offen lds
    s_add_u32 m0, s75, 118784
    s_add_u32 s76, s70, s93
    buffer_load_dwordx4 v11, s[52:55], s76 offen lds
    s_mov_b32 s56, s8
    s_mov_b32 s57, s9
    s_mov_b32 s58, 0x80000
    s_mov_b32 s59, 0x00020000
    v_and_b32 v15, 7, v8
    v_lshl_add_u32 v15, v15, 10, v9
    s_lshl_b32 s78, s65, 11
    s_add_u32 s78, s78, 102400
    s_lshr_b32 s66, s2, 3
    s_and_b32 s67, s2, 7
    s_lshl_b32 s66, s66, 14
    s_lshl_b32 s67, s67, 7
    s_add_u32 s66, s66, s67
    s_and_b32 s67, s65, 1
    s_lshl_b32 s68, s67, 13
    s_lshl_b32 s67, s67, 10
    s_add_u32 m0, s67, 159744
    s_add_u32 s66, s66, s68
    buffer_load_dwordx4 v15, s[56:59], s66 offen lds
    v_bfe_u32 v18, v2, 2, 2
    v_and_b32 v31, 3, v2
    v_bfe_u32 v19, v2, 4, 1
    v_lshlrev_b32 v31, 3, v31
    v_lshl_or_b32 v31, v19, 5, v31
    v_lshrrev_b32 v19, 1, v18
    v_lshl_or_b32 v31, v19, 6, v31
    v_lshl_or_b32 v31, v18, 7, v31
    v_lshrrev_b32 v19, 5, v2
    v_lshl_or_b32 v31, v19, 9, v31
    v_add_u32 v18, s78, v31
    v_xor_b32 v19, 64, v18
    s_cmp_eq_u32 s65, 0
    s_cselect_b32 s82, s82, 0x7ff00000
    s_cselect_b32 s85, 0, 0x7ff00000
    v_mov_b32 v6, 1
    v_lshlrev_b32 v4, 7, v2
    s_add_u32 s86, s85, 21495808
    s_add_u32 s87, s85, 21504000
    s_add_u32 s88, s85, 21512192
    s_add_u32 s89, s85, 21520384
    s_waitcnt vmcnt(4)
    s_barrier
    v_add_u32 v14, 1, v14
    v_max_u32 v14, 1, v14
    s_mov_b64 exec, 1
    buffer_store_dword v14, v5, s[28:31], s84 offen sc1
    s_mov_b64 exec, -1
    s_add_u32 s99, s90, 1
    s_and_b32 s99, s99, 7
    s_lshl_b32 s99, s99, 7
    s_add_u32 s99, s99, s74
    s_add_u32 m0, s75, 16384
    s_add_u32 s76, s99, 0
    buffer_load_dwordx4 v12, s[32:35], s76 offen lds
    s_add_u32 m0, s75, 20480
    s_add_u32 s76, s99, 32768
    buffer_load_dwordx4 v12, s[32:35], s76 offen lds
    s_add_u32 m0, s75, 24576
    s_add_u32 s76, s99, 65536
    buffer_load_dwordx4 v12, s[32:35], s76 offen lds
    s_add_u32 m0, s75, 28672
    s_add_u32 s76, s99, 98304
    buffer_load_dwordx4 v12, s[32:35], s76 offen lds
    s_add_u32 s92, s91, 2
    s_and_b32 s92, s92, 15
    s_mul_i32 s93, s92, 98304
    s_mul_i32 s92, s92, s73
    s_add_u32 m0, s75, 122880
    s_add_u32 s76, s71, s92
    buffer_load_dwordx4 v13, s[44:47], s76 offen lds
    s_add_u32 m0, s75, 126976
    s_add_u32 s76, s69, s92
    buffer_load_dwordx4 v13, s[48:51], s76 offen lds
    s_add_u32 m0, s75, 131072
    s_add_u32 s76, s70, s93
    buffer_load_dwordx4 v11, s[52:55], s76 offen lds
    s_lshr_b32 s66, s63, 2
    s_lshl_b32 s67, s66, 11
    s_lshl_b32 s68, s64, 8
    s_add_u32 s68, s68, s67
    s_add_u32 s67, s67, 16384
    s_lshr_b32 s66, s63, 3
    s_lshl_b32 s66, s66, 13
    s_add_u32 s66, s66, 4096
    v_add_u32 v195, s67, v4
    v_add_u32 v71, s66, v4
    v_and_b32 v72, 1, v2
    v_lshl_add_u32 v72, v72, 7, s68
    v_cmp_gt_u32 vcc, 32, v2
    s_nop 1
    v_cndmask_b32 v71, v72, v71, vcc
    v_cmp_gt_u32 vcc, 16, v2
    s_nop 1
    v_cndmask_b32 v195, v71, v195, vcc
    v_mov_b32 v7, 163824
    s_waitcnt vmcnt(9)
    s_barrier
    v_add_u32 v74, s75, v3
    ds_read_b128 v[112:115], v74 offset:0
    ds_read_b128 v[116:119], v74 offset:4096
    ds_read_b128 v[120:123], v74 offset:8192
    ds_read_b128 v[124:127], v74 offset:12288
    s_add_u32 s92, s91, 3
    s_and_b32 s92, s92, 15
    s_mul_i32 s93, s92, 98304
    s_mul_i32 s92, s92, s73
    s_add_u32 m0, s75, 135168
    s_add_u32 s76, s71, s92
    buffer_load_dwordx4 v13, s[44:47], s76 offen lds
    s_add_u32 m0, s75, 139264
    s_add_u32 s76, s69, s92
    buffer_load_dwordx4 v13, s[48:51], s76 offen lds
    s_add_u32 m0, s75, 143360
    s_add_u32 s76, s70, s93
    buffer_load_dwordx4 v11, s[52:55], s76 offen lds
    s_add_u32 s99, s90, 2
    s_and_b32 s99, s99, 7
    s_lshl_b32 s99, s99, 7
    s_add_u32 s99, s99, s74
    s_add_u32 m0, s75, 32768
    s_add_u32 s76, s99, 0
    buffer_load_dwordx4 v12, s[32:35], s76 offen lds
    s_add_u32 m0, s75, 36864
    s_add_u32 s76, s99, 32768
    buffer_load_dwordx4 v12, s[32:35], s76 offen lds
    s_add_u32 m0, s75, 40960
    s_add_u32 s76, s99, 65536
    buffer_load_dwordx4 v12, s[32:35], s76 offen lds
    s_add_u32 m0, s75, 45056
    s_add_u32 s76, s99, 98304
    buffer_load_dwordx4 v12, s[32:35], s76 offen lds
    s_waitcnt vmcnt(7)
    s_barrier
    s_waitcnt lgkmcnt(0)
    s_add_u32 s92, s91, 4
    s_and_b32 s92, s92, 15
    s_mul_i32 s93, s92, 98304
    s_mul_i32 s92, s92, s73
    s_add_u32 m0, s75, 147456
    s_add_u32 s76, s71, s92
    buffer_load_dwordx4 v13, s[44:47], s76 offen lds
    s_add_u32 m0, s75, 151552
    s_add_u32 s76, s69, s92
    buffer_load_dwordx4 v13, s[48:51], s76 offen lds
    s_add_u32 m0, s75, 155648
    s_add_u32 s76, s70, s93
    buffer_load_dwordx4 v11, s[52:55], s76 offen lds
    s_add_u32 s92, s91, 5
    s_and_b32 s92, s92, 15
    s_mul_i32 s93, s92, 98304
    s_mul_i32 s92, s92, s73
    s_add_u32 m0, s75, 98304
    s_add_u32 s76, s71, s92
    buffer_load_dwordx4 v13, s[44:47], s76 offen lds
    s_add_u32 m0, s75, 102400
    s_add_u32 s76, s69, s92
    buffer_load_dwordx4 v13, s[48:51], s76 offen lds
    s_add_u32 m0, s75, 106496
    s_add_u32 s76, s70, s93
    buffer_load_dwordx4 v11, s[52:55], s76 offen lds
    s_add_u32 s99, s90, 3
    s_and_b32 s99, s99, 7
    s_lshl_b32 s99, s99, 7
    s_add_u32 s99, s99, s74
    s_add_u32 m0, s75, 49152
    s_add_u32 s76, s99, 0
    buffer_load_dwordx4 v12, s[32:35], s76 offen lds
    s_waitcnt vmcnt(11)
    s_barrier
    ds_read_b128 v[128:131], v74 offset:16384
    ds_read_b128 v[132:135], v74 offset:20480
    ds_read_b128 v[136:139], v74 offset:24576
    ds_read_b128 v[140:143], v74 offset:28672
    s_add_u32 m0, s75, 53248
    s_add_u32 s76, s99, 32768
    buffer_load_dwordx4 v12, s[32:35], s76 offen lds
    s_add_u32 m0, s75, 57344
    s_add_u32 s76, s99, 65536
    buffer_load_dwordx4 v12, s[32:35], s76 offen lds
    s_add_u32 m0, s75, 61440
    s_add_u32 s76, s99, 98304
    buffer_load_dwordx4 v12, s[32:35], s76 offen lds
    s_add_u32 s92, s91, 6
    s_and_b32 s92, s92, 15
    s_mul_i32 s93, s92, 98304
    s_mul_i32 s92, s92, s73
    s_add_u32 m0, s75, 110592
    s_add_u32 s76, s71, s92
    buffer_load_dwordx4 v13, s[44:47], s76 offen lds
    s_add_u32 m0, s75, 114688
    s_add_u32 s76, s69, s92
    buffer_load_dwordx4 v13, s[48:51], s76 offen lds
    s_add_u32 m0, s75, 118784
    s_add_u32 s76, s70, s93
    buffer_load_dwordx4 v11, s[52:55], s76 offen lds
    s_add_u32 s92, s91, 7
    s_and_b32 s92, s92, 15
    s_mul_i32 s93, s92, 98304
    s_mul_i32 s92, s92, s73
    s_add_u32 m0, s75, 122880
    s_add_u32 s76, s71, s92
    buffer_load_dwordx4 v13, s[44:47], s76 offen lds
    s_waitcnt vmcnt(11)
    s_barrier
    s_waitcnt lgkmcnt(0)
    s_add_u32 m0, s75, 126976
    s_add_u32 s76, s69, s92
    buffer_load_dwordx4 v13, s[48:51], s76 offen lds
    s_add_u32 m0, s75, 131072
    s_add_u32 s76, s70, s93
    buffer_load_dwordx4 v11, s[52:55], s76 offen lds
    s_add_u32 s99, s90, 4
    s_and_b32 s99, s99, 7
    s_lshl_b32 s99, s99, 7
    s_add_u32 s99, s99, s74
    s_add_u32 m0, s75, 65536
    s_add_u32 s76, s99, 0
    buffer_load_dwordx4 v12, s[32:35], s76 offen lds
    s_add_u32 m0, s75, 69632
    s_add_u32 s76, s99, 32768
    buffer_load_dwordx4 v12, s[32:35], s76 offen lds
    s_add_u32 m0, s75, 73728
    s_add_u32 s76, s99, 65536
    buffer_load_dwordx4 v12, s[32:35], s76 offen lds
    s_add_u32 m0, s75, 77824
    s_add_u32 s76, s99, 98304
    buffer_load_dwordx4 v12, s[32:35], s76 offen lds
    s_add_u32 s92, s91, 8
    s_and_b32 s92, s92, 15
    s_mul_i32 s93, s92, 98304
    s_mul_i32 s92, s92, s73
    s_add_u32 m0, s75, 135168
    s_add_u32 s76, s71, s92
    buffer_load_dwordx4 v13, s[44:47], s76 offen lds
    s_waitcnt vmcnt(35)
    s_mov_b64 exec, 1
    buffer_store_dword v14, v5, s[24:27], s83 offen sc1
    s_mov_b64 exec, -1
    s_waitcnt vmcnt(16)
    s_barrier
    s_add_u32 m0, s75, 139264
    s_add_u32 s76, s69, s92
    buffer_load_dwordx4 v13, s[48:51], s76 offen lds
    s_add_u32 m0, s75, 143360
    s_add_u32 s76, s70, s93
    buffer_load_dwordx4 v11, s[52:55], s76 offen lds
    s_add_u32 s92, s91, 9
    s_and_b32 s92, s92, 15
    s_mul_i32 s93, s92, 98304
    s_mul_i32 s92, s92, s73
    s_add_u32 m0, s75, 147456
    s_add_u32 s76, s71, s92
    buffer_load_dwordx4 v13, s[44:47], s76 offen lds
    s_add_u32 m0, s75, 151552
    s_add_u32 s76, s69, s92
    buffer_load_dwordx4 v13, s[48:51], s76 offen lds
    s_add_u32 m0, s75, 155648
    s_add_u32 s76, s70, s93
    buffer_load_dwordx4 v11, s[52:55], s76 offen lds
    s_add_u32 s99, s90, 5
    s_and_b32 s99, s99, 7
    s_lshl_b32 s99, s99, 7
    s_add_u32 s99, s99, s74
    s_add_u32 m0, s75, 81920
    s_add_u32 s76, s99, 0
    buffer_load_dwordx4 v12, s[32:35], s76 offen lds
    s_add_u32 m0, s75, 86016
    s_add_u32 s76, s99, 32768
    buffer_load_dwordx4 v12, s[32:35], s76 offen lds
    s_waitcnt vmcnt(16)
    s_barrier
    s_add_u32 m0, s75, 90112
    s_add_u32 s76, s99, 65536
    buffer_load_dwordx4 v12, s[32:35], s76 offen lds
    s_add_u32 m0, s75, 94208
    s_add_u32 s76, s99, 98304
    buffer_load_dwordx4 v12, s[32:35], s76 offen lds
    s_add_u32 s92, s91, 10
    s_and_b32 s92, s92, 15
    s_mul_i32 s93, s92, 98304
    s_mul_i32 s92, s92, s73
    s_add_u32 m0, s75, 98304
    s_add_u32 s76, s71, s92
    buffer_load_dwordx4 v13, s[44:47], s76 offen lds
    s_add_u32 m0, s75, 102400
    s_add_u32 s76, s69, s92
    buffer_load_dwordx4 v13, s[48:51], s76 offen lds
    s_add_u32 m0, s75, 106496
    s_add_u32 s76, s70, s93
    buffer_load_dwordx4 v11, s[52:55], s76 offen lds
    s_waitcnt vmcnt(18)
    s_barrier
    s_add_u32 s92, s91, 11
    s_and_b32 s92, s92, 15
    s_mul_i32 s93, s92, 98304
    s_mul_i32 s92, s92, s73
    s_add_u32 m0, s75, 110592
    s_add_u32 s76, s71, s92
    buffer_load_dwordx4 v13, s[44:47], s76 offen lds
    s_add_u32 m0, s75, 114688
    s_add_u32 s76, s69, s92
    buffer_load_dwordx4 v13, s[48:51], s76 offen lds
    s_add_u32 m0, s75, 118784
    s_add_u32 s76, s70, s93
    buffer_load_dwordx4 v11, s[52:55], s76 offen lds
    s_add_u32 s99, s90, 6
    s_and_b32 s99, s99, 7
    s_lshl_b32 s99, s99, 7
    s_add_u32 s99, s99, s74
    s_add_u32 m0, s75, 0
    s_add_u32 s76, s99, 0
    buffer_load_dwordx4 v12, s[32:35], s76 offen lds
    s_add_u32 m0, s75, 4096
    s_add_u32 s76, s99, 32768
    buffer_load_dwordx4 v12, s[32:35], s76 offen lds
    s_add_u32 m0, s75, 8192
    s_add_u32 s76, s99, 65536
    buffer_load_dwordx4 v12, s[32:35], s76 offen lds
    s_add_u32 m0, s75, 12288
    s_add_u32 s76, s99, 98304
    buffer_load_dwordx4 v12, s[32:35], s76 offen lds
    s_waitcnt vmcnt(17)
    s_barrier
    s_add_u32 s92, s91, 12
    s_and_b32 s92, s92, 15
    s_mul_i32 s93, s92, 98304
    s_mul_i32 s92, s92, s73
    s_add_u32 m0, s75, 122880
    s_add_u32 s76, s71, s92
    buffer_load_dwordx4 v13, s[44:47], s76 offen lds
    s_add_u32 m0, s75, 126976
    s_add_u32 s76, s69, s92
    buffer_load_dwordx4 v13, s[48:51], s76 offen lds
    s_add_u32 m0, s75, 131072
    s_add_u32 s76, s70, s93
    buffer_load_dwordx4 v11, s[52:55], s76 offen lds
    s_waitcnt vmcnt(17)
    s_barrier
    s_add_u32 s92, s91, 13
    s_and_b32 s92, s92, 15
    s_mul_i32 s93, s92, 98304
    s_mul_i32 s92, s92, s73
    s_add_u32 m0, s75, 135168
    s_add_u32 s76, s71, s92
    buffer_load_dwordx4 v13, s[44:47], s76 offen lds
    s_add_u32 m0, s75, 139264
    s_add_u32 s76, s69, s92
    buffer_load_dwordx4 v13, s[48:51], s76 offen lds
    s_add_u32 m0, s75, 143360
    s_add_u32 s76, s70, s93
    buffer_load_dwordx4 v11, s[52:55], s76 offen lds
    s_add_u32 s99, s90, 7
    s_and_b32 s99, s99, 7
    s_lshl_b32 s99, s99, 7
    s_add_u32 s99, s99, s74
    s_add_u32 m0, s75, 16384
    s_add_u32 s76, s99, 0
    buffer_load_dwordx4 v12, s[32:35], s76 offen lds
    s_add_u32 m0, s75, 20480
    s_add_u32 s76, s99, 32768
    buffer_load_dwordx4 v12, s[32:35], s76 offen lds
    s_add_u32 m0, s75, 24576
    s_add_u32 s76, s99, 65536
    buffer_load_dwordx4 v12, s[32:35], s76 offen lds
    s_add_u32 m0, s75, 28672
    s_add_u32 s76, s99, 98304
    buffer_load_dwordx4 v12, s[32:35], s76 offen lds
    s_waitcnt vmcnt(17)
    s_barrier
    s_add_u32 s92, s91, 14
    s_and_b32 s92, s92, 15
    s_mul_i32 s93, s92, 98304
    s_mul_i32 s92, s92, s73
    s_add_u32 m0, s75, 147456
    s_add_u32 s76, s71, s92
    buffer_load_dwordx4 v13, s[44:47], s76 offen lds
    s_add_u32 m0, s75, 151552
    s_add_u32 s76, s69, s92
    buffer_load_dwordx4 v13, s[48:51], s76 offen lds
    s_add_u32 m0, s75, 155648
    s_add_u32 s76, s70, s93
    buffer_load_dwordx4 v11, s[52:55], s76 offen lds
    s_cmp_lg_u32 s65, 0
    s_cbranch_scc1 L_nowo2
    ds_read_b64_tr_b16 v[36:37], v18 offset:57344
    ds_read_b64_tr_b16 v[38:39], v18 offset:58368
    ds_read_b64_tr_b16 v[40:41], v19 offset:57344
    ds_read_b64_tr_b16 v[42:43], v19 offset:58368
    s_lshr_b32 s66, s2, 3
    s_and_b32 s67, s2, 7
    s_mul_i32 s67, s67, 294912
    s_lshl_b32 s66, s66, 10
    s_add_u32 s66, s66, s67
    s_add_u32 s66, s66, 16777216
    s_add_u32 s67, s66, 147456
    s_lshl_b32 s68, s60, 11
    s_lshl_b32 s76, s61, 7
    s_add_u32 s68, s68, s76
    s_add_u32 s68, s68, 21561344
    s_lshl_b32 s76, s64, 12
    s_lshl_b32 s77, s63, 7
    s_add_u32 s76, s76, s77
    s_add_u32 s76, s76, 21594112
    v_pk_mul_f32 v[44:45], 0, 0
    v_pk_mul_f32 v[46:47], 0, 0
    s_waitcnt lgkmcnt(0)
    buffer_store_dwordx4 v[36:39], v3, s[28:31], s66 offen sc1
    buffer_store_dwordx4 v[40:43], v3, s[28:31], s67 offen sc1
    s_mov_b64 exec, 1
    buffer_store_dwordx4 v[44:47], v3, s[28:31], s68 offen sc1
    buffer_store_dword v44, v3, s[28:31], s76 offen sc1
    s_mov_b64 exec, -1
L_nowo2:
    s_waitcnt vmcnt(17)
    s_barrier
    s_add_u32 s92, s91, 15
    s_and_b32 s92, s92, 15
    s_mul_i32 s93, s92, 98304
    s_mul_i32 s92, s92, s73
    s_add_u32 m0, s75, 98304
    s_add_u32 s76, s71, s92
    buffer_load_dwordx4 v13, s[44:47], s76 offen lds
    s_add_u32 m0, s75, 102400
    s_add_u32 s76, s69, s92
    buffer_load_dwordx4 v13, s[48:51], s76 offen lds
    s_add_u32 m0, s75, 106496
    s_add_u32 s76, s70, s93
    buffer_load_dwordx4 v11, s[52:55], s76 offen lds
    s_waitcnt vmcnt(13)
    s_barrier
    s_add_u32 s92, s91, 20
    s_and_b32 s92, s92, 15
    s_mul_i32 s92, s92, 114688
    s_add_u32 m0, s75, 110592
    s_add_u32 s76, s70, s92
    buffer_load_dwordx4 v10, s[36:39], s76 offen lds
    s_add_u32 m0, s75, 114688
    s_add_u32 s76, s70, s92
    buffer_load_dwordx4 v10, s[40:43], s76 offen lds
    s_waitcnt vmcnt(12)
    s_barrier
    s_add_u32 s92, s91, 21
    s_and_b32 s92, s92, 15
    s_mul_i32 s92, s92, 114688
    s_add_u32 m0, s75, 118784
    s_add_u32 s76, s70, s92
    buffer_load_dwordx4 v10, s[36:39], s76 offen lds
    s_add_u32 m0, s75, 122880
    s_add_u32 s76, s70, s92
    buffer_load_dwordx4 v10, s[40:43], s76 offen lds
    s_add_u32 s92, s91, 22
    s_and_b32 s92, s92, 15
    s_mul_i32 s92, s92, 114688
    s_add_u32 m0, s75, 126976
    s_add_u32 s76, s70, s92
    buffer_load_dwordx4 v10, s[36:39], s76 offen lds
    s_add_u32 m0, s75, 131072
    s_add_u32 s76, s70, s92
    buffer_load_dwordx4 v10, s[40:43], s76 offen lds
    s_waitcnt vmcnt(9)
    s_barrier
    s_add_u32 s92, s91, 23
    s_and_b32 s92, s92, 15
    s_mul_i32 s92, s92, 114688
    s_add_u32 m0, s75, 135168
    s_add_u32 s76, s70, s92
    buffer_load_dwordx4 v10, s[36:39], s76 offen lds
    s_add_u32 m0, s75, 139264
    s_add_u32 s76, s70, s92
    buffer_load_dwordx4 v10, s[40:43], s76 offen lds
    s_waitcnt vmcnt(8)
    s_barrier
    s_add_u32 s92, s91, 24
    s_and_b32 s92, s92, 15
    s_mul_i32 s92, s92, 114688
    s_add_u32 m0, s75, 143360
    s_add_u32 s76, s70, s92
    buffer_load_dwordx4 v10, s[36:39], s76 offen lds
    s_add_u32 m0, s75, 147456
    s_add_u32 s76, s70, s92
    buffer_load_dwordx4 v10, s[40:43], s76 offen lds
    s_add_u32 s92, s91, 25
    s_and_b32 s92, s92, 15
    s_mul_i32 s92, s92, 114688
    s_add_u32 m0, s75, 151552
    s_add_u32 s76, s70, s92
    buffer_load_dwordx4 v10, s[36:39], s76 offen lds
    s_add_u32 m0, s75, 155648
    s_add_u32 s76, s70, s92
    buffer_load_dwordx4 v10, s[40:43], s76 offen lds
    buffer_load_dword v16, v5, s[24:27], s85 offen sc1
    s_waitcnt vmcnt(11)
    s_barrier
    s_waitcnt vmcnt(9)
    s_barrier
    s_waitcnt vmcnt(7)
    s_barrier
    s_add_u32 s92, s91, 26
    s_and_b32 s92, s92, 15
    s_mul_i32 s92, s92, 114688
    s_add_u32 m0, s75, 110592
    s_add_u32 s76, s70, s92
    buffer_load_dwordx4 v10, s[36:39], s76 offen lds
    s_add_u32 m0, s75, 114688
    s_add_u32 s76, s70, s92
    buffer_load_dwordx4 v10, s[40:43], s76 offen lds
    s_waitcnt vmcnt(7)
    s_barrier
    ds_write_b128 v74, v[112:115] offset:32768
    ds_write_b128 v74, v[116:119] offset:36864
    ds_write_b128 v74, v[120:123] offset:40960
    ds_write_b128 v74, v[124:127] offset:45056
    s_add_u32 s92, s91, 27
    s_and_b32 s92, s92, 15
    s_mul_i32 s92, s92, 114688
    s_add_u32 m0, s75, 118784
    s_add_u32 s76, s70, s92
    buffer_load_dwordx4 v10, s[36:39], s76 offen lds
    s_add_u32 m0, s75, 122880
    s_add_u32 s76, s70, s92
    buffer_load_dwordx4 v10, s[40:43], s76 offen lds
    s_waitcnt vmcnt(7)
    s_barrier
    s_add_u32 s92, s91, 28
    s_and_b32 s92, s92, 15
    s_mul_i32 s92, s92, 114688
    s_add_u32 m0, s75, 126976
    s_add_u32 s76, s70, s92
    buffer_load_dwordx4 v10, s[36:39], s76 offen lds
    s_add_u32 m0, s75, 131072
    s_add_u32 s76, s70, s92
    buffer_load_dwordx4 v10, s[40:43], s76 offen lds
    s_waitcnt vmcnt(7)
    s_barrier
    ds_write_b128 v74, v[128:131] offset:49152
    ds_write_b128 v74, v[132:135] offset:53248
    ds_write_b128 v74, v[136:139] offset:57344
    ds_write_b128 v74, v[140:143] offset:61440
    s_add_u32 s92, s91, 29
    s_and_b32 s92, s92, 15
    s_mul_i32 s92, s92, 114688
    s_add_u32 m0, s75, 135168
    s_add_u32 s76, s70, s92
    buffer_load_dwordx4 v10, s[36:39], s76 offen lds
    s_add_u32 m0, s75, 139264
    s_add_u32 s76, s70, s92
    buffer_load_dwordx4 v10, s[40:43], s76 offen lds
    s_cmp_lg_u32 s65, 0
    s_cbranch_scc1 L_tagdone
    s_waitcnt vmcnt(8)
    v_cmp_eq_u32 vcc, 0, v16
    s_nop 0
    s_cbranch_vccz L_pt_ok
    s_mov_b32 s98, 1048576
L_pt:
    buffer_load_dword v16, v5, s[24:27], 0 offen sc1
    s_waitcnt vmcnt(0)
    v_cmp_eq_u32 vcc, 0, v16
    s_nop 0
    s_cbranch_vccz L_pt_ok
    s_sleep 4
    s_sub_u32 s98, s98, 1
    s_cmp_lg_u32 s98, 0
    s_cbranch_scc1 L_pt
L_pt_ok:
    v_not_b32 v17, v16
L_tagdone:
    s_waitcnt vmcnt(6)
    s_barrier
    s_add_u32 s92, s91, 30
    s_and_b32 s92, s92, 15
    s_mul_i32 s92, s92, 114688
    s_add_u32 m0, s75, 143360
    s_add_u32 s76, s70, s92
    buffer_load_dwordx4 v10, s[36:39], s76 offen lds
    s_add_u32 m0, s75, 147456
    s_add_u32 s76, s70, s92
    buffer_load_dwordx4 v10, s[40:43], s76 offen lds
    s_lshl_b32 s66, s65, 1
    s_add_u32 s66, s66, s62
    s_cmp_lg_u32 s66, 0
    s_cbranch_scc1 L_f1done0
    s_mov_b64 exec, 1
    buffer_store_dwordx2 v[16:17], v5, s[28:31], s82 offen sc1
    s_mov_b64 exec, -1
L_f1done0:
    s_lshl_b32 s66, s65, 1
    s_add_u32 s66, s66, s62
    s_cmp_lg_u32 s66, 1
    s_cbranch_scc1 L_f1done1
    s_mov_b64 exec, 1
    buffer_store_dwordx2 v[16:17], v5, s[28:31], s82 offen sc1
    s_mov_b64 exec, -1
L_f1done1:
    s_waitcnt vmcnt(6)
    s_barrier
    s_add_u32 s92, s91, 31
    s_and_b32 s92, s92, 15
    s_mul_i32 s92, s92, 114688
    s_add_u32 m0, s75, 151552
    s_add_u32 s76, s70, s92
    buffer_load_dwordx4 v10, s[36:39], s76 offen lds
    s_add_u32 m0, s75, 155648
    s_add_u32 s76, s70, s92
    buffer_load_dwordx4 v10, s[40:43], s76 offen lds
    s_waitcnt vmcnt(6)
    s_barrier
    s_add_u32 s92, s91, 32
    s_and_b32 s92, s92, 15
    s_mul_i32 s92, s92, 114688
    s_add_u32 m0, s75, 110592
    s_add_u32 s76, s70, s92
    buffer_load_dwordx4 v10, s[36:39], s76 offen lds
    s_add_u32 m0, s75, 114688
    s_add_u32 s76, s70, s92
    buffer_load_dwordx4 v10, s[40:43], s76 offen lds
    s_mov_b32 s44, s16
    s_mov_b32 s45, s17
    s_mov_b32 s46, 0x1c0000
    s_mov_b32 s47, 0x00020000
    s_mov_b32 s48, s18
    s_mov_b32 s49, s19
    s_mov_b32 s50, 0x400
    s_mov_b32 s51, 0x00020000
    s_mul_i32 s66, s63, 3
    s_add_u32 s66, s66, s65
    s_add_u32 s67, s63, 96
    s_cmp_eq_u32 s65, 3
    s_cselect_b32 s66, s67, s66
    s_lshl_b32 s69, s66, 14
    s_lshl_b32 s68, s64, 7
    s_mov_b32 m0, s78
    s_add_u32 s69, s69, s68
    buffer_load_dwordx4 v15, s[44:47], s69 offen lds
    s_add_u32 m0, s78, 1024
    s_add_u32 s69, s69, 8192
    buffer_load_dwordx4 v15, s[44:47], s69 offen lds
    s_mul_i32 s79, s64, 294912
    s_lshl_b32 s67, s66, 10
    s_add_u32 s79, s79, s67
    s_add_u32 s79, s79, 16809984
    s_cmp_lt_u32 s66, 112
    s_cselect_b32 s79, s79, 0x7ff00000
    s_add_u32 s80, s79, 147456
    s_lshl_b32 s71, s60, 7
    s_lshl_b32 s67, s61, 3
    s_add_u32 s71, s71, s67
    s_lshl_b32 s67, s65, 1
    s_add_u32 s71, s71, s67
    s_lshl_b32 s67, s71, 10
    buffer_load_dwordx4 v[48:51], v3, s[32:35], s67 offen
    buffer_load_dwordx4 v[52:55], v3, s[32:35], s67 offen offset:1024
    buffer_load_dwordx4 v[56:59], v3, s[48:51], 0 offen
    s_waitcnt vmcnt(11)
    s_barrier
    s_add_u32 s92, s91, 33
    s_and_b32 s92, s92, 15
    s_mul_i32 s92, s92, 114688
    s_add_u32 m0, s75, 118784
    s_add_u32 s76, s70, s92
    buffer_load_dwordx4 v10, s[36:39], s76 offen lds
    s_add_u32 m0, s75, 122880
    s_add_u32 s76, s70, s92
    buffer_load_dwordx4 v10, s[40:43], s76 offen lds
    s_waitcnt vmcnt(11)
    s_barrier
    s_add_u32 s92, s91, 34
    s_and_b32 s92, s92, 15
    s_mul_i32 s92, s92, 114688
    s_add_u32 m0, s75, 126976
    s_add_u32 s76, s70, s92
    buffer_load_dwordx4 v10, s[36:39], s76 offen lds
    s_add_u32 m0, s75, 131072
    s_add_u32 s76, s70, s92
    buffer_load_dwordx4 v10, s[40:43], s76 offen lds
    s_waitcnt vmcnt(11)
    s_barrier
    s_waitcnt lgkmcnt(0)
    s_add_u32 s92, s91, 35
    s_and_b32 s92, s92, 15
    s_mul_i32 s92, s92, 114688
    s_add_u32 m0, s75, 135168
    s_add_u32 s76, s70, s92
    buffer_load_dwordx4 v10, s[36:39], s76 offen lds
    s_add_u32 m0, s75, 139264
    s_add_u32 s76, s70, s92
    buffer_load_dwordx4 v10, s[40:43], s76 offen lds
    s_waitcnt vmcnt(11)
    s_barrier
    buffer_load_dwordx2 v[204:205], v195, s[28:31], s86 offen sc1
    s_waitcnt vmcnt(1)
    s_barrier
    s_cmp_ge_u32 s65, 2
    s_cbranch_scc1 L_nocs
    v_and_b32 v8, 255, v0
    v_lshrrev_b32 v9, 2, v8
    v_mul_u32_u24 v9, 1104, v9
    v_and_b32 v8, 3, v8
    v_mul_u32_u24 v8, v8, v8
    v_min_u32 v8, 4, v8
    v_lshl_add_u32 v9, v8, 4, v9
    v_add_u32 v9, 66560, v9
    v_mov_b32 v32, 0x3f803f80
    v_cmp_eq_u32 vcc, 0, v8
    s_nop 1
    v_cndmask_b32 v32, 0, v32, vcc
    v_mov_b32 v33, v32
    ds_write_b64 v9, v[32:33]
    ds_write_b64 v9, v[32:33] offset:8
L_nocs:
    s_lshl_b32 s56, s63, 16
    s_lshl_b32 s67, s64, 13
    s_lshl_b32 s57, s65, 11
    s_add_u32 s59, s67, s57
    s_mul_i32 s58, s65, 2208
    v_mov_b32 v192, v16
    v_mov_b32 v193, v17
    s_cmp_lg_u32 s65, 0
    s_cbranch_scc1 L_wl
    s_waitcnt vmcnt(0)
    v_xor_b32 v204, v204, v192
    v_xor_b32 v205, v205, v193
    v_or_b32 v204, v204, v205
    v_cmp_ne_u32 vcc, 0, v204
    s_nop 0
    s_cbranch_vccz L_ps1_ok
    s_mov_b32 s98, 1048576
L_ps1:
    buffer_load_dwordx2 v[204:205], v195, s[28:31], s86 offen sc1
    s_waitcnt vmcnt(0)
    v_xor_b32 v204, v204, v192
    v_xor_b32 v205, v205, v193
    v_or_b32 v204, v204, v205
    v_cmp_ne_u32 vcc, 0, v204
    s_nop 0
    s_cbranch_vccz L_ps1_ok
    s_sleep 4
    s_sub_u32 s98, s98, 1
    s_cmp_lg_u32 s98, 0
    s_cbranch_scc1 L_ps1
L_ps1_ok:
    ds_write_b32 v7, v6
    s_branch L_wl_ok
L_wl:
    s_mov_b32 s98, 8388608
L_wl2:
    ds_read_b32 v8, v7
    s_waitcnt lgkmcnt(0)
    v_cmp_ne_u32 vcc, 1, v8
    s_nop 0
    s_cbranch_vccz L_wl_ok
    s_sleep 1
    s_sub_u32 s98, s98, 1
    s_cmp_lg_u32 s98, 0
    s_cbranch_scc1 L_wl2
L_wl_ok:
    s_add_u32 s67, s59, s56
    s_add_u32 m0, s57, 143360
    s_add_u32 s67, s67, 0
    buffer_load_dwordx4 v3, s[28:31], s67 offen offset:0 sc1 lds
    buffer_load_dwordx4 v3, s[28:31], s67 offen offset:1024 sc1 lds
    s_add_u32 s94, s59, 0
    s_and_b32 s94, s94, 0xffff
    s_add_u32 s94, s94, s56
    s_add_u32 m0, s57, 0
    s_add_u32 s67, s94, 2097152
    buffer_load_dwordx4 v3, s[28:31], s67 offen offset:0 sc1 lds
    buffer_load_dwordx4 v3, s[28:31], s67 offen offset:1024 sc1 lds
    s_add_u32 s67, s94, 4194304
    s_add_u32 m0, s58, 65536
    s_nop 0
    buffer_load_dwordx4 v3, s[28:31], s67 offen offset:0 sc1 lds
    s_add_u32 m0, s58, 65616
    s_nop 0
    buffer_load_dwordx4 v3, s[28:31], s67 offen offset:1024 sc1 lds
    s_add_u32 s94, s59, 8192
    s_and_b32 s94, s94, 0xffff
    s_add_u32 s94, s94, s56
    s_add_u32 m0, s57, 8192
    s_add_u32 s67, s94, 2097152
    buffer_load_dwordx4 v3, s[28:31], s67 offen offset:0 sc1 lds
    buffer_load_dwordx4 v3, s[28:31], s67 offen offset:1024 sc1 lds
    s_add_u32 s67, s94, 4194304
    s_add_u32 m0, s58, 74368
    s_nop 0
    buffer_load_dwordx4 v3, s[28:31], s67 offen offset:0 sc1 lds
    s_add_u32 m0, s58, 74448
    s_nop 0
    buffer_load_dwordx4 v3, s[28:31], s67 offen offset:1024 sc1 lds
    s_waitcnt vmcnt(17)
    ds_read_b64_tr_b16 v[224:225], v18 offset:0
    ds_read_b64_tr_b16 v[226:227], v18 offset:1024
    ds_read_b64_tr_b16 v[228:229], v19 offset:0
    ds_read_b64_tr_b16 v[230:231], v19 offset:1024
    v_mov_b32 v64, 0
    v_mov_b32 v65, 0
    v_dot2_f32_bf16 v64, v48, v56, v64
    v_dot2_f32_bf16 v65, v52, v56, v65
    v_dot2_f32_bf16 v64, v49, v57, v64
    v_dot2_f32_bf16 v65, v53, v57, v65
    v_dot2_f32_bf16 v64, v50, v58, v64
    v_dot2_f32_bf16 v65, v54, v58, v65
    v_dot2_f32_bf16 v64, v51, v59, v64
    v_dot2_f32_bf16 v65, v55, v59, v65
    v_cmp_eq_u32 vcc, 0, v2
    s_waitcnt lgkmcnt(0)
    v_add_f32_dpp v64, v64, v64 quad_perm:[1,0,3,2] row_mask:0xf bank_mask:0xf
    v_add_f32_dpp v65, v65, v65 quad_perm:[1,0,3,2] row_mask:0xf bank_mask:0xf
    s_nop 0
    v_add_f32_dpp v64, v64, v64 quad_perm:[2,3,0,1] row_mask:0xf bank_mask:0xf
    v_add_f32_dpp v65, v65, v65 quad_perm:[2,3,0,1] row_mask:0xf bank_mask:0xf
    s_nop 0
    v_add_f32_dpp v64, v64, v64 row_half_mirror row_mask:0xf bank_mask:0xf
    v_add_f32_dpp v65, v65, v65 row_half_mirror row_mask:0xf bank_mask:0xf
    s_nop 0
    v_add_f32_dpp v64, v64, v64 row_mirror row_mask:0xf bank_mask:0xf
    v_add_f32_dpp v65, v65, v65 row_mirror row_mask:0xf bank_mask:0xf
    v_readlane_b32 s66, v64, 0
    v_readlane_b32 s67, v64, 16
    v_readlane_b32 s68, v64, 32
    v_readlane_b32 s69, v64, 48
    v_readlane_b32 s52, v65, 0
    v_readlane_b32 s53, v65, 16
    v_readlane_b32 s54, v65, 32
    v_readlane_b32 s55, v65, 48
    v_mov_b32 v66, s66
    v_mov_b32 v67, s52
    v_add_f32 v66, s67, v66
    v_add_f32 v67, s53, v67
    v_add_f32 v66, s68, v66
    v_add_f32 v67, s54, v67
    v_add_f32 v66, s69, v66
    v_add_f32 v67, s55, v67
    v_cndmask_b32 v66, v67, v66, vcc
    v_mul_f32 v66, 0xbfb8aa3b, v66
    v_exp_f32 v66, v66
    v_lshlrev_b32 v68, 2, v2
    v_add_f32 v66, 1.0, v66
    v_rcp_f32 v66, v66
    s_lshl_b32 s71, s71, 2
    s_add_u32 s71, s71, 20971520
    s_mov_b64 exec, 3
    buffer_store_dword v66, v68, s[28:31], s71 offen sc1
    s_mov_b64 exec, -1
    s_mov_b32 s36, s79
    s_mov_b32 s37, s80
    v_mov_b32 v232, -1
    v_mov_b32 v233, -1
    v_mov_b32 v234, -1
    v_mov_b32 v235, -1
    v_mov_b32 v236, -1
    v_mov_b32 v237, -1
    v_mov_b32 v238, -1
    v_mov_b32 v239, -1
    s_lshl_b32 s38, s64, 3
    s_lshl_b32 s68, s65, 1
    s_add_u32 s38, s38, s68
    s_mul_i32 s38, s38, 147456
    s_lshl_b32 s68, s63, 10
    s_add_u32 s38, s38, s68
    s_add_u32 s38, s38, 6291456
    s_add_u32 s39, s38, 147456
    s_and_b32 s65, s3, 3
    s_lshr_b32 s66, s3, 2
    s_lshl_b32 s67, s66, 10
    v_add_u32 v4, s67, v3
    v_add_u32 v80, 0, v2
    v_and_b32 v80, 15, v80
    v_lshrrev_b32 v81, 5, v2
    v_lshl_or_b32 v80, v81, 4, v80
    v_lshlrev_b32 v80, 4, v80
    v_add_u32 v81, 512, v80
    v_and_b32 v82, 31, v2
    v_subrev_u32 v83, 20, v82
    v_cmp_gt_u32 vcc, 8, v83
    v_mov_b32 v83, 1040
    v_mov_b32 v84, 1088
    v_cndmask_b32 v83, v83, v84, vcc
    v_cmp_eq_u32 vcc, 16, v82
    v_mov_b32 v84, 1024
    s_nop 0
    v_cndmask_b32 v83, v83, v84, vcc
    v_cmp_gt_u32 vcc, 16, v82
    s_nop 1
    v_cndmask_b32 v80, v83, v80, vcc
    v_cndmask_b32 v81, v83, v81, vcc
    s_mul_i32 s67, s66, 1104
    s_add_u32 s67, s67, 65536
    v_add_u32 v5, s67, v80
    v_add_u32 v6, s67, v81
    s_lshl_b32 s67, s65, 11
    s_add_u32 s67, s67, 143360
    v_add_u32 v8, s67, v3
    s_lshl_b32 s73, s60, 11
    s_lshl_b32 s74, s61, 7
    s_add_u32 s73, s73, s74
    s_add_u32 s73, s73, 21561344
    s_lshl_b32 s72, s64, 12
    s_lshl_b32 s75, s63, 7
    s_add_u32 s72, s72, s75
    s_add_u32 s72, s72, 21594112
    s_lshr_b32 s74, s63, 1
    s_lshl_b32 s74, s74, 11
    s_add_u32 s74, s74, 21561344
    s_lshl_b32 s95, s64, 12
    s_lshr_b32 s89, s63, 2
    s_lshl_b32 s89, s89, 12
    s_sub_u32 s89, s89, 4096
    s_mov_b32 s88, 21594112
    s_and_b32 s68, s3, 1
    s_lshr_b32 s69, s3, 1
    s_lshl_b32 s84, s63, 1
    s_add_u32 s84, s84, s68
    s_mul_i32 s85, s84, 147456
    s_add_u32 s85, s85, 6291456
    s_mul_i32 s86, s64, 294912
    s_add_u32 s86, s86, 16777216
    s_mul_i32 s75, s69, 28672
    s_add_u32 s75, s75, 32768
    s_add_u32 s76, s85, s75
    s_add_u32 s77, s86, s75
    s_add_u32 s78, s77, 147456
    s_lshl_b32 s75, s69, 13
    s_add_u32 s85, s85, s75
    s_add_u32 s86, s86, s75
    v_mov_b32 v7, v3
    s_lshl_b32 s79, s64, 3
    s_lshl_b32 s80, s65, 1
    s_add_u32 s79, s79, s80
    s_add_u32 s79, s79, s66
    s_mul_i32 s81, s79, 147456
    s_lshl_b32 s80, s63, 10
    s_add_u32 s81, s81, s80
    s_add_u32 s81, s81, 6291456
    s_lshl_b32 s87, s84, 7
    s_add_u32 s87, s87, 20971520
    s_mul_i32 s79, s3, 2304
    s_add_u32 s79, s79, 136192
    s_xor_b32 s80, s3, 4
    s_lshl_b32 s82, s3, 2
    s_lshl_b32 s83, s80, 2
    s_mul_i32 s80, s80, 2304
    s_add_u32 s80, s80, 136192
    s_add_u32 s82, s82, 163776
    s_add_u32 s83, s83, 163776
    s_lshl_b32 s90, s63, 16
    s_lshl_b32 s91, s3, 10
    s_mul_i32 s92, s3, 1104
    s_lshl_b32 s93, s64, 13
    s_add_u32 s93, s93, s91
    v_and_b32 v80, 255, v0
    v_lshrrev_b32 v189, 2, v80
    v_mul_u32_u24 v189, 1104, v189
    v_and_b32 v80, 3, v80
    v_mul_u32_u24 v80, v80, v80
    v_min_u32 v80, 4, v80
    v_lshl_add_u32 v189, v80, 4, v189
    v_add_u32 v189, 66560, v189
    v_mov_b32 v190, 0x3f803f80
    v_cmp_eq_u32 vcc, 0, v80
    s_nop 1
    v_cndmask_b32 v190, 0, v190, vcc
    v_mov_b32 v191, v190
    s_branch L_attn
L_compute:
    s_and_b32 s65, s3, 1
    s_lshr_b32 s66, s3, 1
    v_and_b32 v8, 31, v2
    v_lshrrev_b32 v62, 5, v2
    v_bfe_u32 v5, v2, 1, 3
    v_xor_b32 v5, v5, v62
    s_lshl_b32 s67, s65, 13
    v_lshl_add_u32 v6, v8, 7, s67
    v_xor_b32 v7, 0, v5
    v_lshl_add_u32 v56, v7, 4, v6
    v_xor_b32 v7, 2, v5
    v_lshl_add_u32 v57, v7, 4, v6
    v_xor_b32 v7, 4, v5
    v_lshl_add_u32 v58, v7, 4, v6
    v_xor_b32 v7, 6, v5
    v_lshl_add_u32 v59, v7, 4, v6
    v_bfe_u32 v5, v2, 2, 2
    v_and_b32 v6, 3, v2
    v_bfe_u32 v7, v2, 4, 1
    v_lshlrev_b32 v6, 3, v6
    v_lshl_or_b32 v6, v7, 5, v6
    v_lshrrev_b32 v7, 1, v5
    v_lshl_or_b32 v6, v7, 6, v6
    v_lshl_or_b32 v6, v5, 7, v6
    v_lshl_or_b32 v6, v62, 10, v6
    s_lshl_b32 s67, s66, 6
    v_xor_b32 v6, s67, v6
    v_add_u32 v60, 98304, v6
    v_pk_mul_f32 v[96:97], 0, 0
    v_pk_mul_f32 v[98:99], 0, 0
    v_pk_mul_f32 v[100:101], 0, 0
    v_pk_mul_f32 v[102:103], 0, 0
    v_pk_mul_f32 v[104:105], 0, 0
    v_pk_mul_f32 v[106:107], 0, 0
    v_pk_mul_f32 v[108:109], 0, 0
    v_pk_mul_f32 v[110:111], 0, 0
    v_pk_mul_f32 v[112:113], 0, 0
    v_pk_mul_f32 v[114:115], 0, 0
    v_pk_mul_f32 v[116:117], 0, 0
    v_pk_mul_f32 v[118:119], 0, 0
    v_pk_mul_f32 v[120:121], 0, 0
    v_pk_mul_f32 v[122:123], 0, 0
    v_pk_mul_f32 v[124:125], 0, 0
    v_pk_mul_f32 v[126:127], 0, 0
    v_pk_mul_f32 v[128:129], 0, 0
    v_pk_mul_f32 v[130:131], 0, 0
    v_pk_mul_f32 v[132:133], 0, 0
    v_pk_mul_f32 v[134:135], 0, 0
    v_pk_mul_f32 v[136:137], 0, 0
    v_pk_mul_f32 v[138:139], 0, 0
    v_pk_mul_f32 v[140:141], 0, 0
    v_pk_mul_f32 v[142:143], 0, 0
    v_pk_mul_f32 v[144:145], 0, 0
    v_pk_mul_f32 v[146:147], 0, 0
    v_pk_mul_f32 v[148:149], 0, 0
    v_pk_mul_f32 v[150:151], 0, 0
    v_pk_mul_f32 v[152:153], 0, 0
    v_pk_mul_f32 v[154:155], 0, 0
    v_pk_mul_f32 v[156:157], 0, 0
    v_pk_mul_f32 v[158:159], 0, 0
    v_pk_mul_f32 v[160:161], 0, 0
    v_pk_mul_f32 v[162:163], 0, 0
    v_pk_mul_f32 v[164:165], 0, 0
    v_pk_mul_f32 v[166:167], 0, 0
    v_pk_mul_f32 v[168:169], 0, 0
    v_pk_mul_f32 v[170:171], 0, 0
    v_pk_mul_f32 v[172:173], 0, 0
    v_pk_mul_f32 v[174:175], 0, 0
    v_pk_mul_f32 v[176:177], 0, 0
    v_pk_mul_f32 v[178:179], 0, 0
    v_pk_mul_f32 v[180:181], 0, 0
    v_pk_mul_f32 v[182:183], 0, 0
    v_pk_mul_f32 v[184:185], 0, 0
    v_pk_mul_f32 v[186:187], 0, 0
    v_pk_mul_f32 v[188:189], 0, 0
    v_pk_mul_f32 v[190:191], 0, 0
    v_pk_mul_f32 v[192:193], 0, 0
    v_pk_mul_f32 v[194:195], 0, 0
    v_pk_mul_f32 v[196:197], 0, 0
    v_pk_mul_f32 v[198:199], 0, 0
    v_pk_mul_f32 v[200:201], 0, 0
    v_pk_mul_f32 v[202:203], 0, 0
    v_pk_mul_f32 v[204:205], 0, 0
    v_pk_mul_f32 v[206:207], 0, 0
    v_pk_mul_f32 v[208:209], 0, 0
    v_pk_mul_f32 v[210:211], 0, 0
    v_pk_mul_f32 v[212:213], 0, 0
    v_pk_mul_f32 v[214:215], 0, 0
    v_pk_mul_f32 v[216:217], 0, 0
    v_pk_mul_f32 v[218:219], 0, 0
    v_pk_mul_f32 v[220:221], 0, 0
    v_pk_mul_f32 v[222:223], 0, 0
    v_pk_mul_f32 v[224:225], 0, 0
    v_pk_mul_f32 v[226:227], 0, 0
    v_pk_mul_f32 v[228:229], 0, 0
    v_pk_mul_f32 v[230:231], 0, 0
    v_pk_mul_f32 v[232:233], 0, 0
    v_pk_mul_f32 v[234:235], 0, 0
    v_pk_mul_f32 v[236:237], 0, 0
    v_pk_mul_f32 v[238:239], 0, 0
    v_pk_mul_f32 v[240:241], 0, 0
    v_pk_mul_f32 v[242:243], 0, 0
    v_pk_mul_f32 v[244:245], 0, 0
    v_pk_mul_f32 v[246:247], 0, 0
    v_pk_mul_f32 v[248:249], 0, 0
    v_pk_mul_f32 v[250:251], 0, 0
    v_pk_mul_f32 v[252:253], 0, 0
    v_pk_mul_f32 v[254:255], 0, 0
    v_mov_b32 v5, 163824
    ds_write_b128 v5, v[96:99]
    v_mov_b32 v14, 163808
    v_mov_b32 v15, 1
    ds_write_b32 v14, v96
    v_mov_b32 v5, 163776
    ds_write_b128 v5, v[96:99]
    ds_write_b128 v5, v[96:99] offset:16
    s_mov_b32 s51, 0xffff4000
    s_mov_b32 s52, 0xfffec000
    s_mov_b32 s46, 0
    s_mov_b32 s47, 0
    s_mov_b32 s48, 8
    s_waitcnt lgkmcnt(0)
    s_lshl_b32 s68, s60, 2
    s_lshl_b32 s69, s65, 1
    s_add_u32 s69, s68, s69
    v_add_u32 v9, 0, v2
    v_and_b32 v9, 15, v9
    v_lshl_or_b32 v9, v62, 4, v9
    v_lshlrev_b32 v9, 4, v9
    v_bfe_u32 v10, v2, 4, 1
    v_lshl_or_b32 v9, v10, 16, v9
    s_lshr_b32 s44, s61, 2
    s_lshl_b32 s44, s44, 19
    s_lshl_b32 s45, s66, 17
    s_add_u32 s44, s44, s45
    s_lshl_b32 s45, s69, 10
    s_add_u32 s44, s44, s45
    s_add_u32 s44, s44, 4194304
    s_add_u32 s45, s44, 262144
    s_cmp_lt_u32 s61, 8
    s_cselect_b32 s53, 0x3eb8aa3b, 1.0
    s_lshl_b32 s67, s61, 2
    s_lshl_b32 s68, s66, 1
    s_add_u32 s67, s67, s68
    s_lshl_b32 s67, s67, 16
    s_lshl_b32 s68, s69, 10
    s_add_u32 s67, s67, s68
    s_add_u32 s54, s67, 0
    s_add_u32 s55, s54, 0x10000
    s_mul_i32 s67, s69, 147456
    s_lshl_b32 s68, s66, 11
    s_add_u32 s67, s67, s68
    s_add_u32 s67, s67, 6324224
    s_lshl_b32 s68, s61, 12
    s_add_u32 s68, s67, s68
    s_add_u32 s36, s68, 0
    s_add_u32 s37, s68, 1024
    s_add_u32 s38, s68, 147456
    s_add_u32 s39, s68, 148480
    s_lshl_b32 s68, s81, 12
    s_add_u32 s68, s67, s68
    s_add_u32 s40, s68, 0
    s_add_u32 s41, s68, 1024
    s_add_u32 s42, s68, 147456
    s_add_u32 s43, s68, 148480
    v_mov_b32 v10, 0xbdd2d3e8
    v_mov_b32 v11, 0xbdd2d3e8
    v_mov_b32 v12, 0xc0135761
    v_mov_b32 v13, 0xc0135761
    s_and_b32 s65, s3, 3
    s_lshr_b32 s66, s3, 2
    s_lshl_b32 s67, s66, 10
    v_add_u32 v4, s67, v3
    v_add_u32 v80, 0, v2
    v_and_b32 v80, 15, v80
    v_lshrrev_b32 v81, 5, v2
    v_lshl_or_b32 v80, v81, 4, v80
    v_lshlrev_b32 v80, 4, v80
    v_add_u32 v81, 512, v80
    v_and_b32 v82, 31, v2
    v_subrev_u32 v83, 20, v82
    v_cmp_gt_u32 vcc, 8, v83
    v_mov_b32 v83, 1040
    v_mov_b32 v84, 1088
    v_cndmask_b32 v83, v83, v84, vcc
    v_cmp_eq_u32 vcc, 16, v82
    v_mov_b32 v84, 1024
    s_nop 0
    v_cndmask_b32 v83, v83, v84, vcc
    v_cmp_gt_u32 vcc, 16, v82
    s_nop 1
    v_cndmask_b32 v80, v83, v80, vcc
    v_cndmask_b32 v81, v83, v81, vcc
    s_mul_i32 s67, s66, 1104
    s_add_u32 s67, s67, 65536
    v_add_u32 v5, s67, v80
    v_add_u32 v6, s67, v81
    s_lshl_b32 s67, s65, 11
    s_add_u32 s67, s67, 143360
    v_add_u32 v8, s67, v3
    s_lshl_b32 s73, s60, 11
    s_lshl_b32 s74, s61, 7
    s_add_u32 s73, s73, s74
    s_add_u32 s73, s73, 21561344
    s_lshl_b32 s72, s64, 12
    s_lshl_b32 s75, s63, 7
    s_add_u32 s72, s72, s75
    s_add_u32 s72, s72, 21594112
    s_lshr_b32 s74, s63, 1
    s_lshl_b32 s74, s74, 11
    s_add_u32 s74, s74, 21561344
    s_lshl_b32 s95, s64, 12
    s_lshr_b32 s89, s63, 2
    s_lshl_b32 s89, s89, 12
    s_sub_u32 s89, s89, 4096
    s_mov_b32 s88, 21594112
    s_and_b32 s68, s3, 1
    s_lshr_b32 s69, s3, 1
    s_lshl_b32 s84, s63, 1
    s_add_u32 s84, s84, s68
    s_mul_i32 s85, s84, 147456
    s_add_u32 s85, s85, 6291456
    s_mul_i32 s86, s64, 294912
    s_add_u32 s86, s86, 16777216
    s_mul_i32 s75, s69, 28672
    s_add_u32 s75, s75, 32768
    s_add_u32 s76, s85, s75
    s_add_u32 s77, s86, s75
    s_add_u32 s78, s77, 147456
    s_lshl_b32 s75, s69, 13
    s_add_u32 s85, s85, s75
    s_add_u32 s86, s86, s75
    v_mov_b32 v7, v3
    s_lshl_b32 s79, s64, 3
    s_lshl_b32 s80, s65, 1
    s_add_u32 s79, s79, s80
    s_add_u32 s79, s79, s66
    s_mul_i32 s81, s79, 147456
    s_lshl_b32 s80, s63, 10
    s_add_u32 s81, s81, s80
    s_add_u32 s81, s81, 6291456
    s_lshl_b32 s87, s84, 7
    s_add_u32 s87, s87, 20971520
    s_mul_i32 s79, s3, 2304
    s_add_u32 s79, s79, 136192
    s_xor_b32 s80, s3, 4
    s_lshl_b32 s82, s3, 2
    s_lshl_b32 s83, s80, 2
    s_mul_i32 s80, s80, 2304
    s_add_u32 s80, s80, 136192
    s_add_u32 s82, s82, 163776
    s_add_u32 s83, s83, 163776
    s_lshl_b32 s90, s63, 16
    s_lshl_b32 s91, s3, 10
    s_mul_i32 s92, s3, 1104
    s_lshl_b32 s93, s64, 13
    s_add_u32 s93, s93, s91
    s_barrier
    ds_read_b128 v[16:19], v56 offset:0
    ds_read_b64_tr_b16 v[24:25], v60 offset:0
    ds_read_b64_tr_b16 v[26:27], v60 offset:512
    ds_read_b128 v[20:23], v56 offset:4096
    ds_read_b64_tr_b16 v[28:29], v60 offset:4096
    ds_read_b64_tr_b16 v[30:31], v60 offset:4608
    ds_read_b64_tr_b16 v[32:33], v60 offset:8192
    ds_read_b64_tr_b16 v[34:35], v60 offset:8704
    s_cmp_eq_u32 s62, 1
    s_cbranch_scc1 L_p1loopV
L_p1loopA:
    s_waitcnt lgkmcnt(5)
    v_mfma_f32_32x32x16_bf16 v[96:111], v[24:27], v[16:19], v[96:111]
    ds_read_b128 v[36:39], v57 offset:0
    ds_read_b64_tr_b16 v[44:45], v60 offset:2048
    s_waitcnt lgkmcnt(6)
    v_mfma_f32_32x32x16_bf16 v[160:175], v[24:27], v[20:23], v[160:175]
    ds_read_b64_tr_b16 v[46:47], v60 offset:2560
    ds_read_b128 v[40:43], v57 offset:4096
    s_waitcnt lgkmcnt(6)
    v_mfma_f32_32x32x16_bf16 v[128:143], v[28:31], v[16:19], v[128:143]
    ds_read_b64_tr_b16 v[48:49], v60 offset:6144
    ds_read_b64_tr_b16 v[50:51], v60 offset:6656
    v_mfma_f32_32x32x16_bf16 v[192:207], v[28:31], v[20:23], v[192:207]
    ds_read_b64_tr_b16 v[52:53], v60 offset:10240
    ds_read_b64_tr_b16 v[54:55], v60 offset:10752
    s_add_u32 s46, s46, 1
    s_cmp_eq_u32 s46, 5
    s_cselect_b32 s49, s51, 12288
    s_cselect_b32 s46, 0, s46
    v_add_u32 v60, s49, v60
    s_waitcnt lgkmcnt(8)
    v_mfma_f32_32x32x16_bf16 v[224:239], v[32:35], v[16:19], v[224:239]
    v_mfma_f32_32x32x16_bf16 v[240:255], v[32:35], v[20:23], v[240:255]
    s_waitcnt lgkmcnt(5)
    v_mfma_f32_32x32x16_bf16 v[96:111], v[44:47], v[36:39], v[96:111]
    s_waitcnt lgkmcnt(4)
    v_mfma_f32_32x32x16_bf16 v[160:175], v[44:47], v[40:43], v[160:175]
    s_waitcnt lgkmcnt(0)
    v_mfma_f32_32x32x16_bf16 v[128:143], v[48:51], v[36:39], v[128:143]
    s_barrier
    ds_read_b128 v[16:19], v58 offset:0
    ds_read_b64_tr_b16 v[24:25], v60 offset:0
    v_mfma_f32_32x32x16_bf16 v[192:207], v[48:51], v[40:43], v[192:207]
    ds_read_b64_tr_b16 v[26:27], v60 offset:512
    ds_read_b128 v[20:23], v58 offset:4096
    v_mfma_f32_32x32x16_bf16 v[224:239], v[52:55], v[36:39], v[224:239]
    ds_read_b64_tr_b16 v[28:29], v60 offset:4096
    ds_read_b64_tr_b16 v[30:31], v60 offset:4608
    v_mfma_f32_32x32x16_bf16 v[240:255], v[52:55], v[40:43], v[240:255]
    ds_read_b64_tr_b16 v[32:33], v60 offset:8192
    ds_read_b64_tr_b16 v[34:35], v60 offset:8704
    s_waitcnt lgkmcnt(5)
    v_mfma_f32_32x32x16_bf16 v[96:111], v[24:27], v[16:19], v[96:111]
    ds_read_b128 v[36:39], v59 offset:0
    ds_read_b64_tr_b16 v[44:45], v60 offset:2048
    s_waitcnt lgkmcnt(6)
    v_mfma_f32_32x32x16_bf16 v[160:175], v[24:27], v[20:23], v[160:175]
    ds_read_b64_tr_b16 v[46:47], v60 offset:2560
    ds_read_b128 v[40:43], v59 offset:4096
    s_waitcnt lgkmcnt(6)
    v_mfma_f32_32x32x16_bf16 v[128:143], v[28:31], v[16:19], v[128:143]
    ds_read_b64_tr_b16 v[48:49], v60 offset:6144
    ds_read_b64_tr_b16 v[50:51], v60 offset:6656
    v_mfma_f32_32x32x16_bf16 v[192:207], v[28:31], v[20:23], v[192:207]
    ds_read_b64_tr_b16 v[52:53], v60 offset:10240
    ds_read_b64_tr_b16 v[54:55], v60 offset:10752
    s_add_u32 s46, s46, 1
    s_cmp_eq_u32 s46, 5
    s_cselect_b32 s49, s51, 12288
    s_cselect_b32 s46, 0, s46
    v_add_u32 v60, s49, v60
    s_waitcnt lgkmcnt(8)
    v_mfma_f32_32x32x16_bf16 v[224:239], v[32:35], v[16:19], v[224:239]
    s_add_u32 s47, s47, 1
    s_cmp_eq_u32 s47, 6
    s_cselect_b32 s50, s52, 16384
    s_cselect_b32 s47, 0, s47
    v_add_u32 v56, s50, v56
    v_mfma_f32_32x32x16_bf16 v[240:255], v[32:35], v[20:23], v[240:255]
    s_waitcnt lgkmcnt(5)
    v_mfma_f32_32x32x16_bf16 v[96:111], v[44:47], v[36:39], v[96:111]
    v_add_u32 v57, s50, v57
    v_add_u32 v58, s50, v58
    v_add_u32 v59, s50, v59
    s_waitcnt lgkmcnt(4)
    v_mfma_f32_32x32x16_bf16 v[160:175], v[44:47], v[40:43], v[160:175]
    s_sub_u32 s48, s48, 1
    s_cmp_lg_u32 s48, 0
    s_waitcnt lgkmcnt(0)
    v_mfma_f32_32x32x16_bf16 v[128:143], v[48:51], v[36:39], v[128:143]
    s_barrier
    ds_read_b128 v[16:19], v56 offset:0
    ds_read_b64_tr_b16 v[24:25], v60 offset:0
    v_mfma_f32_32x32x16_bf16 v[192:207], v[48:51], v[40:43], v[192:207]
    ds_read_b64_tr_b16 v[26:27], v60 offset:512
    ds_read_b128 v[20:23], v56 offset:4096
    v_mfma_f32_32x32x16_bf16 v[224:239], v[52:55], v[36:39], v[224:239]
    ds_read_b64_tr_b16 v[28:29], v60 offset:4096
    ds_read_b64_tr_b16 v[30:31], v60 offset:4608
    v_mfma_f32_32x32x16_bf16 v[240:255], v[52:55], v[40:43], v[240:255]
    ds_read_b64_tr_b16 v[32:33], v60 offset:8192
    ds_read_b64_tr_b16 v[34:35], v60 offset:8704
    s_cbranch_scc1 L_p1loopA
    v_add_u32 v56, 0x4000, v56
    ds_read_b128 v[36:39], v57 offset:0
    ds_read_b64_tr_b16 v[44:45], v60 offset:2048
    ds_read_b64_tr_b16 v[46:47], v60 offset:2560
    ds_read_b128 v[40:43], v57 offset:4096
    ds_read_b64_tr_b16 v[48:49], v60 offset:6144
    ds_read_b64_tr_b16 v[50:51], v60 offset:6656
    v_add_u32 v57, 0x4000, v57
    s_waitcnt lgkmcnt(8)
    v_mfma_f32_32x32x16_bf16 v[112:127], v[24:27], v[16:19], v[112:127]
    s_barrier
    ds_read_b128 v[72:75], v58 offset:0
    ds_read_b64_tr_b16 v[80:81], v60 offset:8192
    v_mfma_f32_32x32x16_bf16 v[176:191], v[24:27], v[20:23], v[176:191]
    ds_read_b64_tr_b16 v[82:83], v60 offset:8704
    ds_read_b128 v[76:79], v58 offset:4096
    v_mfma_f32_32x32x16_bf16 v[144:159], v[28:31], v[16:19], v[144:159]
    ds_read_b64_tr_b16 v[84:85], v60 offset:12288
    ds_read_b64_tr_b16 v[86:87], v60 offset:12800
    v_mfma_f32_32x32x16_bf16 v[208:223], v[28:31], v[20:23], v[208:223]
    v_add_u32 v58, 0x4000, v58
    s_waitcnt lgkmcnt(6)
    v_mfma_f32_32x32x16_bf16 v[112:127], v[44:47], v[36:39], v[112:127]
    ds_read_b128 v[16:19], v59 offset:0
    ds_read_b64_tr_b16 v[24:25], v60 offset:10240
    v_mul_f32 v224, s53, v224
    v_mul_f32 v225, s53, v225
    v_mul_f32 v226, s53, v226
    v_mfma_f32_32x32x16_bf16 v[176:191], v[44:47], v[40:43], v[176:191]
    ds_read_b64_tr_b16 v[26:27], v60 offset:10752
    ds_read_b128 v[20:23], v59 offset:4096
    v_mul_f32 v227, s53, v227
    v_mul_f32 v228, s53, v228
    v_mul_f32 v229, s53, v229
    v_mul_f32 v230, s53, v230
    v_mfma_f32_32x32x16_bf16 v[144:159], v[48:51], v[36:39], v[144:159]
    ds_read_b64_tr_b16 v[28:29], v60 offset:14336
    ds_read_b64_tr_b16 v[30:31], v60 offset:14848
    v_mul_f32 v231, s53, v231
    v_cvt_pk_bf16_f32 v224, v224, v225
    v_cvt_pk_bf16_f32 v225, v226, v227
    v_cvt_pk_bf16_f32 v226, v228, v229
    v_mfma_f32_32x32x16_bf16 v[208:223], v[48:51], v[40:43], v[208:223]
    v_add_u32 v59, 0x4000, v59
    v_cvt_pk_bf16_f32 v227, v230, v231
    buffer_store_dwordx4 v[224:227], v3, s[28:31], s54 offen offset:0 sc1
    v_mul_f32 v232, s53, v232
    v_mul_f32 v233, s53, v233
    v_mul_f32 v234, s53, v234
    s_waitcnt lgkmcnt(6)
    v_mfma_f32_32x32x16_bf16 v[112:127], v[80:83], v[72:75], v[112:127]
    s_barrier
    ds_read_b128 v[36:39], v56 offset:0
    ds_read_b64_tr_b16 v[44:45], v60 offset:16384
    v_mul_f32 v235, s53, v235
    v_mul_f32 v236, s53, v236
    v_mfma_f32_32x32x16_bf16 v[176:191], v[80:83], v[76:79], v[176:191]
    ds_read_b64_tr_b16 v[46:47], v60 offset:16896
    ds_read_b128 v[40:43], v56 offset:4096
    v_mul_f32 v237, s53, v237
    v_mul_f32 v238, s53, v238
    v_mul_f32 v239, s53, v239
    v_cvt_pk_bf16_f32 v232, v232, v233
    v_mfma_f32_32x32x16_bf16 v[144:159], v[84:87], v[72:75], v[144:159]
    ds_read_b64_tr_b16 v[48:49], v60 offset:20480
    ds_read_b64_tr_b16 v[50:51], v60 offset:20992
    v_cvt_pk_bf16_f32 v233, v234, v235
    v_cvt_pk_bf16_f32 v234, v236, v237
    v_cvt_pk_bf16_f32 v235, v238, v239
    buffer_store_dwordx4 v[232:235], v3, s[28:31], s55 offen offset:0 sc1
    v_mfma_f32_32x32x16_bf16 v[208:223], v[84:87], v[76:79], v[208:223]
    v_add_u32 v56, 0x4000, v56
    v_mul_f32 v240, s53, v240
    v_mul_f32 v241, s53, v241
    v_mul_f32 v242, s53, v242
    v_mul_f32 v243, s53, v243
    v_mul_f32 v244, s53, v244
    s_waitcnt lgkmcnt(6)
    v_mfma_f32_32x32x16_bf16 v[112:127], v[24:27], v[16:19], v[112:127]
    ds_read_b128 v[72:75], v57 offset:0
    ds_read_b64_tr_b16 v[80:81], v60 offset:18432
    v_mul_f32 v245, s53, v245
    v_mul_f32 v246, s53, v246
    v_mul_f32 v247, s53, v247
    v_mfma_f32_32x32x16_bf16 v[176:191], v[24:27], v[20:23], v[176:191]
    ds_read_b64_tr_b16 v[82:83], v60 offset:18944
    ds_read_b128 v[76:79], v57 offset:4096
    v_cvt_pk_bf16_f32 v240, v240, v241
    v_cvt_pk_bf16_f32 v241, v242, v243
    v_cvt_pk_bf16_f32 v242, v244, v245
    v_cvt_pk_bf16_f32 v243, v246, v247
    v_mfma_f32_32x32x16_bf16 v[144:159], v[28:31], v[16:19], v[144:159]
    ds_read_b64_tr_b16 v[84:85], v60 offset:22528
    ds_read_b64_tr_b16 v[86:87], v60 offset:23040
    buffer_store_dwordx4 v[240:243], v3, s[28:31], s54 offen offset:1024 sc1
    v_mul_f32 v248, s53, v248
    v_mul_f32 v249, s53, v249
    v_mul_f32 v250, s53, v250
    v_mfma_f32_32x32x16_bf16 v[208:223], v[28:31], v[20:23], v[208:223]
    v_add_u32 v57, 0x4000, v57
    v_mul_f32 v251, s53, v251
    v_mul_f32 v252, s53, v252
    v_mul_f32 v253, s53, v253
    v_mul_f32 v254, s53, v254
    v_mul_f32 v255, s53, v255
    s_waitcnt lgkmcnt(6)
    v_mfma_f32_32x32x16_bf16 v[112:127], v[44:47], v[36:39], v[112:127]
    s_barrier
    ds_read_b128 v[16:19], v58 offset:0
    ds_read_b64_tr_b16 v[24:25], v60 offset:24576
    v_cvt_pk_bf16_f32 v248, v248, v249
    v_cvt_pk_bf16_f32 v249, v250, v251
    v_mfma_f32_32x32x16_bf16 v[176:191], v[44:47], v[40:43], v[176:191]
    ds_read_b64_tr_b16 v[26:27], v60 offset:25088
    ds_read_b128 v[20:23], v58 offset:4096
    v_cvt_pk_bf16_f32 v250, v252, v253
    v_cvt_pk_bf16_f32 v251, v254, v255
    buffer_store_dwordx4 v[248:251], v3, s[28:31], s55 offen offset:1024 sc1
    v_mul_f32 v64, v96, v96
    v_mfma_f32_32x32x16_bf16 v[144:159], v[48:51], v[36:39], v[144:159]
    ds_read_b64_tr_b16 v[28:29], v60 offset:28672
    ds_read_b64_tr_b16 v[30:31], v60 offset:29184
    v_mul_f32 v65, v97, v97
    v_mul_f32 v66, v98, v98
    v_mul_f32 v67, v99, v99
    v_fma_f32 v64, v64, v10, v12
    v_mfma_f32_32x32x16_bf16 v[208:223], v[48:51], v[40:43], v[208:223]
    v_add_u32 v58, 0x4000, v58
    v_fma_f32 v65, v65, v10, v12
    v_fma_f32 v66, v66, v10, v12
    v_fma_f32 v67, v67, v10, v12
    v_mul_f32 v64, v64, v96
    v_mul_f32 v65, v65, v97
    s_waitcnt lgkmcnt(6)
    v_mfma_f32_32x32x16_bf16 v[112:127], v[80:83], v[72:75], v[112:127]
    ds_read_b128 v[36:39], v59 offset:0
    ds_read_b64_tr_b16 v[44:45], v60 offset:26624
    v_mul_f32 v66, v66, v98
    v_mul_f32 v67, v67, v99
    v_mfma_f32_32x32x16_bf16 v[176:191], v[80:83], v[76:79], v[176:191]
    ds_read_b64_tr_b16 v[46:47], v60 offset:27136
    ds_read_b128 v[40:43], v59 offset:4096
    v_exp_f32 v64, v64
    v_mul_f32 v128, v128, v96
    v_mfma_f32_32x32x16_bf16 v[144:159], v[84:87], v[72:75], v[144:159]
    ds_read_b64_tr_b16 v[48:49], v60 offset:30720
    ds_read_b64_tr_b16 v[50:51], v60 offset:31232
    v_exp_f32 v65, v65
    v_mul_f32 v129, v129, v97
    v_mfma_f32_32x32x16_bf16 v[208:223], v[84:87], v[76:79], v[208:223]
    v_add_u32 v59, 0x4000, v59
    v_exp_f32 v66, v66
    v_mul_f32 v130, v130, v98
    v_exp_f32 v67, v67
    s_waitcnt lgkmcnt(6)
    v_mfma_f32_32x32x16_bf16 v[112:127], v[24:27], v[16:19], v[112:127]
    s_barrier
    ds_read_b128 v[72:75], v56 offset:0
    ds_read_b64_tr_b16 v[80:81], v60 offset:32768
    v_mul_f32 v131, v131, v99
    v_add_f32 v64, 1.0, v64
    v_mfma_f32_32x32x16_bf16 v[176:191], v[24:27], v[20:23], v[176:191]
    ds_read_b64_tr_b16 v[82:83], v60 offset:33280
    ds_read_b128 v[76:79], v56 offset:4096
    v_add_f32 v65, 1.0, v65
    v_add_f32 v66, 1.0, v66
    v_add_f32 v67, 1.0, v67
    v_mfma_f32_32x32x16_bf16 v[144:159], v[28:31], v[16:19], v[144:159]
    ds_read_b64_tr_b16 v[84:85], v60 offset:36864
    ds_read_b64_tr_b16 v[86:87], v60 offset:37376
    v_rcp_f32 v64, v64
    v_rcp_f32 v65, v65
    v_mfma_f32_32x32x16_bf16 v[208:223], v[28:31], v[20:23], v[208:223]
    v_add_u32 v56, 0x4000, v56
    v_rcp_f32 v66, v66
    v_rcp_f32 v67, v67
    v_mul_f32 v128, v128, v64
    s_waitcnt lgkmcnt(6)
    v_mfma_f32_32x32x16_bf16 v[112:127], v[44:47], v[36:39], v[112:127]
    ds_read_b128 v[16:19], v57 offset:0
    ds_read_b64_tr_b16 v[24:25], v60 offset:34816
    v_mul_f32 v129, v129, v65
    v_mul_f32 v130, v130, v66
    v_mul_f32 v131, v131, v67
    v_mfma_f32_32x32x16_bf16 v[176:191], v[44:47], v[40:43], v[176:191]
    ds_read_b64_tr_b16 v[26:27], v60 offset:35328
    ds_read_b128 v[20:23], v57 offset:4096
    v_cvt_pk_bf16_f32 v240, v128, v129
    v_cvt_pk_bf16_f32 v241, v130, v131
    v_mul_f32 v68, v100, v100
    v_mul_f32 v69, v101, v101
    v_mfma_f32_32x32x16_bf16 v[144:159], v[48:51], v[36:39], v[144:159]
    ds_read_b64_tr_b16 v[28:29], v60 offset:38912
    ds_read_b64_tr_b16 v[30:31], v60 offset:39424
    v_mul_f32 v70, v102, v102
    v_mul_f32 v71, v103, v103
    v_fma_f32 v68, v68, v10, v12
    v_fma_f32 v69, v69, v10, v12
    v_mfma_f32_32x32x16_bf16 v[208:223], v[48:51], v[40:43], v[208:223]
    v_add_u32 v57, 0x4000, v57
    v_fma_f32 v70, v70, v10, v12
    v_fma_f32 v71, v71, v10, v12
    v_mul_f32 v68, v68, v100
    v_mul_f32 v69, v69, v101
    v_mul_f32 v70, v70, v102
    s_waitcnt lgkmcnt(6)
    v_mfma_f32_32x32x16_bf16 v[112:127], v[80:83], v[72:75], v[112:127]
    s_barrier
    ds_read_b128 v[36:39], v58 offset:0
    ds_read_b64_tr_b16 v[44:45], v60 offset:40960
    v_mul_f32 v71, v71, v103
    v_mfma_f32_32x32x16_bf16 v[176:191], v[80:83], v[76:79], v[176:191]
    ds_read_b64_tr_b16 v[46:47], v60 offset:41472
    ds_read_b128 v[40:43], v58 offset:4096
    v_exp_f32 v68, v68
    v_mul_f32 v132, v132, v100
    v_mfma_f32_32x32x16_bf16 v[144:159], v[84:87], v[72:75], v[144:159]
    ds_read_b64_tr_b16 v[48:49], v60 offset:45056
    ds_read_b64_tr_b16 v[50:51], v60 offset:45568
    v_exp_f32 v69, v69
    v_mul_f32 v133, v133, v101
    v_mfma_f32_32x32x16_bf16 v[208:223], v[84:87], v[76:79], v[208:223]
    v_add_u32 v58, 0x4000, v58
    v_exp_f32 v70, v70
    v_mul_f32 v134, v134, v102
    v_exp_f32 v71, v71
    s_waitcnt lgkmcnt(6)
    v_mfma_f32_32x32x16_bf16 v[112:127], v[24:27], v[16:19], v[112:127]
    ds_read_b128 v[72:75], v59 offset:0
    ds_read_b64_tr_b16 v[80:81], v60 offset:43008
    v_mul_f32 v135, v135, v103
    v_add_f32 v68, 1.0, v68
    v_add_f32 v69, 1.0, v69
    v_mfma_f32_32x32x16_bf16 v[176:191], v[24:27], v[20:23], v[176:191]
    ds_read_b64_tr_b16 v[82:83], v60 offset:43520
    ds_read_b128 v[76:79], v59 offset:4096
    v_add_f32 v70, 1.0, v70
    v_add_f32 v71, 1.0, v71
    v_rcp_f32 v68, v68
    v_mfma_f32_32x32x16_bf16 v[144:159], v[28:31], v[16:19], v[144:159]
    ds_read_b64_tr_b16 v[84:85], v60 offset:47104
    ds_read_b64_tr_b16 v[86:87], v60 offset:47616
    v_rcp_f32 v69, v69
    v_rcp_f32 v70, v70
    v_mfma_f32_32x32x16_bf16 v[208:223], v[28:31], v[20:23], v[208:223]
    v_add_u32 v59, 0x4000, v59
    v_rcp_f32 v71, v71
    v_mul_f32 v132, v132, v68
    v_mul_f32 v133, v133, v69
    v_mul_f32 v134, v134, v70
    s_waitcnt lgkmcnt(6)
    v_mfma_f32_32x32x16_bf16 v[112:127], v[44:47], v[36:39], v[112:127]
    s_waitcnt vmcnt(0)
    s_barrier
    ds_read_b128 v[16:19], v56 offset:0
    ds_read_b64_tr_b16 v[24:25], v60 offset:0
    v_mul_f32 v135, v135, v71
    v_mfma_f32_32x32x16_bf16 v[176:191], v[44:47], v[40:43], v[176:191]
    ds_read_b64_tr_b16 v[26:27], v60 offset:512
    ds_read_b128 v[20:23], v56 offset:4096
    v_cvt_pk_bf16_f32 v242, v132, v133
    v_cvt_pk_bf16_f32 v243, v134, v135
    v_mul_f32 v64, v104, v104
    v_mul_f32 v65, v105, v105
    v_mfma_f32_32x32x16_bf16 v[144:159], v[48:51], v[36:39], v[144:159]
    ds_read_b64_tr_b16 v[28:29], v60 offset:4096
    ds_read_b64_tr_b16 v[30:31], v60 offset:4608
    v_mul_f32 v66, v106, v106
    v_mul_f32 v67, v107, v107
    v_fma_f32 v64, v64, v10, v12
    v_fma_f32 v65, v65, v10, v12
    v_mfma_f32_32x32x16_bf16 v[208:223], v[48:51], v[40:43], v[208:223]
    v_add_u32 v56, 0xfffec000, v56
    v_fma_f32 v66, v66, v10, v12
    v_fma_f32 v67, v67, v10, v12
    v_mul_f32 v64, v64, v104
    v_mul_f32 v65, v65, v105
    v_mul_f32 v66, v66, v106
    s_waitcnt lgkmcnt(6)
    v_mfma_f32_32x32x16_bf16 v[112:127], v[80:83], v[72:75], v[112:127]
    ds_read_b128 v[36:39], v57 offset:0
    ds_read_b64_tr_b16 v[44:45], v60 offset:2048
    v_mul_f32 v67, v67, v107
    v_exp_f32 v64, v64
    v_mfma_f32_32x32x16_bf16 v[176:191], v[80:83], v[76:79], v[176:191]
    ds_read_b64_tr_b16 v[46:47], v60 offset:2560
    ds_read_b128 v[40:43], v57 offset:4096
    v_mul_f32 v136, v136, v104
    v_exp_f32 v65, v65
    v_mul_f32 v137, v137, v105
    v_mfma_f32_32x32x16_bf16 v[144:159], v[84:87], v[72:75], v[144:159]
    ds_read_b64_tr_b16 v[48:49], v60 offset:6144
    ds_read_b64_tr_b16 v[50:51], v60 offset:6656
    v_exp_f32 v66, v66
    v_mul_f32 v138, v138, v106
    v_mfma_f32_32x32x16_bf16 v[208:223], v[84:87], v[76:79], v[208:223]
    v_add_u32 v57, 0xfffec000, v57
    v_exp_f32 v67, v67
    v_mul_f32 v139, v139, v107
    v_add_f32 v64, 1.0, v64
    v_add_f32 v65, 1.0, v65
    s_waitcnt lgkmcnt(6)
    v_mfma_f32_32x32x16_bf16 v[112:127], v[24:27], v[16:19], v[112:127]
    s_barrier
    ds_read_b128 v[72:75], v58 offset:0
    ds_read_b64_tr_b16 v[80:81], v60 offset:8192
    v_add_f32 v66, 1.0, v66
    v_add_f32 v67, 1.0, v67
    v_mfma_f32_32x32x16_bf16 v[176:191], v[24:27], v[20:23], v[176:191]
    ds_read_b64_tr_b16 v[82:83], v60 offset:8704
    ds_read_b128 v[76:79], v58 offset:4096
    v_rcp_f32 v64, v64
    v_rcp_f32 v65, v65
    v_mfma_f32_32x32x16_bf16 v[144:159], v[28:31], v[16:19], v[144:159]
    ds_read_b64_tr_b16 v[84:85], v60 offset:12288
    ds_read_b64_tr_b16 v[86:87], v60 offset:12800
    v_rcp_f32 v66, v66
    v_rcp_f32 v67, v67
    v_mfma_f32_32x32x16_bf16 v[208:223], v[28:31], v[20:23], v[208:223]
    v_add_u32 v58, 0xfffec000, v58
    v_mul_f32 v136, v136, v64
    v_mul_f32 v137, v137, v65
    v_mul_f32 v138, v138, v66
    v_mul_f32 v139, v139, v67
    v_cvt_pk_bf16_f32 v244, v136, v137
    s_waitcnt lgkmcnt(6)
    v_mfma_f32_32x32x16_bf16 v[112:127], v[44:47], v[36:39], v[112:127]
    ds_read_b128 v[16:19], v59 offset:0
    ds_read_b64_tr_b16 v[24:25], v60 offset:10240
    v_cvt_pk_bf16_f32 v245, v138, v139
    v_mul_f32 v68, v108, v108
    v_mul_f32 v69, v109, v109
    v_mfma_f32_32x32x16_bf16 v[176:191], v[44:47], v[40:43], v[176:191]
    ds_read_b64_tr_b16 v[26:27], v60 offset:10752
    ds_read_b128 v[20:23], v59 offset:4096
    v_mul_f32 v70, v110, v110
    v_mul_f32 v71, v111, v111
    v_fma_f32 v68, v68, v10, v12
    v_fma_f32 v69, v69, v10, v12
    v_mfma_f32_32x32x16_bf16 v[144:159], v[48:51], v[36:39], v[144:159]
    ds_read_b64_tr_b16 v[28:29], v60 offset:14336
    ds_read_b64_tr_b16 v[30:31], v60 offset:14848
    v_fma_f32 v70, v70, v10, v12
    v_fma_f32 v71, v71, v10, v12
    v_mul_f32 v68, v68, v108
    v_mul_f32 v69, v69, v109
    v_mfma_f32_32x32x16_bf16 v[208:223], v[48:51], v[40:43], v[208:223]
    v_add_u32 v59, 0xfffec000, v59
    v_mul_f32 v70, v70, v110
    v_mul_f32 v71, v71, v111
    v_exp_f32 v68, v68
    v_mul_f32 v140, v140, v108
    s_waitcnt lgkmcnt(6)
    v_mfma_f32_32x32x16_bf16 v[112:127], v[80:83], v[72:75], v[112:127]
    s_barrier
    ds_read_b128 v[36:39], v56 offset:0
    ds_read_b64_tr_b16 v[44:45], v60 offset:16384
    v_exp_f32 v69, v69
    v_mfma_f32_32x32x16_bf16 v[176:191], v[80:83], v[76:79], v[176:191]
    ds_read_b64_tr_b16 v[46:47], v60 offset:16896
    ds_read_b128 v[40:43], v56 offset:4096
    v_mul_f32 v141, v141, v109
    v_exp_f32 v70, v70
    v_mul_f32 v142, v142, v110
    v_mfma_f32_32x32x16_bf16 v[144:159], v[84:87], v[72:75], v[144:159]
    ds_read_b64_tr_b16 v[48:49], v60 offset:20480
    ds_read_b64_tr_b16 v[50:51], v60 offset:20992
    v_exp_f32 v71, v71
    v_mul_f32 v143, v143, v111
    v_add_f32 v68, 1.0, v68
    v_mfma_f32_32x32x16_bf16 v[208:223], v[84:87], v[76:79], v[208:223]
    v_add_u32 v56, 0x4000, v56
    v_add_f32 v69, 1.0, v69
    v_add_f32 v70, 1.0, v70
    v_add_f32 v71, 1.0, v71
    v_rcp_f32 v68, v68
    s_waitcnt lgkmcnt(6)
    v_mfma_f32_32x32x16_bf16 v[112:127], v[24:27], v[16:19], v[112:127]
    ds_read_b128 v[72:75], v57 offset:0
    ds_read_b64_tr_b16 v[80:81], v60 offset:18432
    v_rcp_f32 v69, v69
    v_mfma_f32_32x32x16_bf16 v[176:191], v[24:27], v[20:23], v[176:191]
    ds_read_b64_tr_b16 v[82:83], v60 offset:18944
    ds_read_b128 v[76:79], v57 offset:4096
    v_rcp_f32 v70, v70
    v_rcp_f32 v71, v71
    v_mfma_f32_32x32x16_bf16 v[144:159], v[28:31], v[16:19], v[144:159]
    ds_read_b64_tr_b16 v[84:85], v60 offset:22528
    ds_read_b64_tr_b16 v[86:87], v60 offset:23040
    v_mul_f32 v140, v140, v68
    v_mul_f32 v141, v141, v69
    v_mul_f32 v142, v142, v70
    v_mul_f32 v143, v143, v71
    v_mfma_f32_32x32x16_bf16 v[208:223], v[28:31], v[20:23], v[208:223]
    v_add_u32 v57, 0x4000, v57
    v_cvt_pk_bf16_f32 v246, v140, v141
    v_cvt_pk_bf16_f32 v247, v142, v143
    v_mul_f32 v64, v160, v160
    v_mul_f32 v65, v161, v161
    v_mul_f32 v66, v162, v162
    s_waitcnt lgkmcnt(6)
    v_mfma_f32_32x32x16_bf16 v[112:127], v[44:47], v[36:39], v[112:127]
    s_barrier
    ds_read_b128 v[16:19], v58 offset:0
    ds_read_b64_tr_b16 v[24:25], v60 offset:24576
    v_mul_f32 v67, v163, v163
    v_fma_f32 v64, v64, v10, v12
    v_mfma_f32_32x32x16_bf16 v[176:191], v[44:47], v[40:43], v[176:191]
    ds_read_b64_tr_b16 v[26:27], v60 offset:25088
    ds_read_b128 v[20:23], v58 offset:4096
    v_fma_f32 v65, v65, v10, v12
    v_fma_f32 v66, v66, v10, v12
    v_fma_f32 v67, v67, v10, v12
    v_mul_f32 v64, v64, v160
    v_mfma_f32_32x32x16_bf16 v[144:159], v[48:51], v[36:39], v[144:159]
    ds_read_b64_tr_b16 v[28:29], v60 offset:28672
    ds_read_b64_tr_b16 v[30:31], v60 offset:29184
    v_mul_f32 v65, v65, v161
    v_mul_f32 v66, v66, v162
    v_mul_f32 v67, v67, v163
    v_mfma_f32_32x32x16_bf16 v[208:223], v[48:51], v[40:43], v[208:223]
    v_add_u32 v58, 0x4000, v58
    v_exp_f32 v64, v64
    v_mul_f32 v192, v192, v160
    v_exp_f32 v65, v65
    s_waitcnt lgkmcnt(6)
    v_mfma_f32_32x32x16_bf16 v[112:127], v[80:83], v[72:75], v[112:127]
    ds_read_b128 v[36:39], v59 offset:0
    ds_read_b64_tr_b16 v[44:45], v60 offset:26624
    v_mul_f32 v193, v193, v161
    v_exp_f32 v66, v66
    v_mfma_f32_32x32x16_bf16 v[176:191], v[80:83], v[76:79], v[176:191]
    ds_read_b64_tr_b16 v[46:47], v60 offset:27136
    ds_read_b128 v[40:43], v59 offset:4096
    v_mul_f32 v194, v194, v162
    v_exp_f32 v67, v67
    v_mul_f32 v195, v195, v163
    v_mfma_f32_32x32x16_bf16 v[144:159], v[84:87], v[72:75], v[144:159]
    ds_read_b64_tr_b16 v[48:49], v60 offset:30720
    ds_read_b64_tr_b16 v[50:51], v60 offset:31232
    v_add_f32 v64, 1.0, v64
    v_add_f32 v65, 1.0, v65
    v_add_f32 v66, 1.0, v66
    v_add_f32 v67, 1.0, v67
    v_mfma_f32_32x32x16_bf16 v[208:223], v[84:87], v[76:79], v[208:223]
    v_add_u32 v59, 0x4000, v59
    v_rcp_f32 v64, v64
    v_rcp_f32 v65, v65
    s_waitcnt lgkmcnt(6)
    v_mfma_f32_32x32x16_bf16 v[112:127], v[24:27], v[16:19], v[112:127]
    s_barrier
    ds_read_b128 v[72:75], v56 offset:0
    ds_read_b64_tr_b16 v[80:81], v60 offset:32768
    v_rcp_f32 v66, v66
    v_mfma_f32_32x32x16_bf16 v[176:191], v[24:27], v[20:23], v[176:191]
    ds_read_b64_tr_b16 v[82:83], v60 offset:33280
    ds_read_b128 v[76:79], v56 offset:4096
    v_rcp_f32 v67, v67
    v_mul_f32 v192, v192, v64
    v_mul_f32 v193, v193, v65
    v_mfma_f32_32x32x16_bf16 v[144:159], v[28:31], v[16:19], v[144:159]
    ds_read_b64_tr_b16 v[84:85], v60 offset:36864
    ds_read_b64_tr_b16 v[86:87], v60 offset:37376
    v_mul_f32 v194, v194, v66
    v_mul_f32 v195, v195, v67
    v_cvt_pk_bf16_f32 v248, v192, v193
    v_cvt_pk_bf16_f32 v249, v194, v195
    v_mfma_f32_32x32x16_bf16 v[208:223], v[28:31], v[20:23], v[208:223]
    v_add_u32 v56, 0x4000, v56
    v_mul_f32 v68, v164, v164
    v_mul_f32 v69, v165, v165
    v_mul_f32 v70, v166, v166
    v_mul_f32 v71, v167, v167
    v_fma_f32 v68, v68, v10, v12
    s_waitcnt lgkmcnt(6)
    v_mfma_f32_32x32x16_bf16 v[112:127], v[44:47], v[36:39], v[112:127]
    ds_read_b128 v[16:19], v57 offset:0
    ds_read_b64_tr_b16 v[24:25], v60 offset:34816
    v_fma_f32 v69, v69, v10, v12
    v_fma_f32 v70, v70, v10, v12
    v_fma_f32 v71, v71, v10, v12
    v_mfma_f32_32x32x16_bf16 v[176:191], v[44:47], v[40:43], v[176:191]
    ds_read_b64_tr_b16 v[26:27], v60 offset:35328
    ds_read_b128 v[20:23], v57 offset:4096
    v_mul_f32 v68, v68, v164
    v_mul_f32 v69, v69, v165
    v_mul_f32 v70, v70, v166
    v_mul_f32 v71, v71, v167
    v_mfma_f32_32x32x16_bf16 v[144:159], v[48:51], v[36:39], v[144:159]
    ds_read_b64_tr_b16 v[28:29], v60 offset:38912
    ds_read_b64_tr_b16 v[30:31], v60 offset:39424
    v_exp_f32 v68, v68
    v_mul_f32 v196, v196, v164
    v_mfma_f32_32x32x16_bf16 v[208:223], v[48:51], v[40:43], v[208:223]
    v_add_u32 v57, 0x4000, v57
    v_exp_f32 v69, v69
    v_mul_f32 v197, v197, v165
    v_exp_f32 v70, v70
    s_waitcnt lgkmcnt(6)
    v_mfma_f32_32x32x16_bf16 v[112:127], v[80:83], v[72:75], v[112:127]
    s_barrier
    ds_read_b128 v[36:39], v58 offset:0
    ds_read_b64_tr_b16 v[44:45], v60 offset:40960
    v_mul_f32 v198, v198, v166
    v_mfma_f32_32x32x16_bf16 v[176:191], v[80:83], v[76:79], v[176:191]
    ds_read_b64_tr_b16 v[46:47], v60 offset:41472
    ds_read_b128 v[40:43], v58 offset:4096
    v_exp_f32 v71, v71
    v_mul_f32 v199, v199, v167
    v_add_f32 v68, 1.0, v68
    v_mfma_f32_32x32x16_bf16 v[144:159], v[84:87], v[72:75], v[144:159]
    ds_read_b64_tr_b16 v[48:49], v60 offset:45056
    ds_read_b64_tr_b16 v[50:51], v60 offset:45568
    v_add_f32 v69, 1.0, v69
    v_add_f32 v70, 1.0, v70
    v_add_f32 v71, 1.0, v71
    v_mfma_f32_32x32x16_bf16 v[208:223], v[84:87], v[76:79], v[208:223]
    v_add_u32 v58, 0x4000, v58
    v_rcp_f32 v68, v68
    v_rcp_f32 v69, v69
    s_waitcnt lgkmcnt(6)
    v_mfma_f32_32x32x16_bf16 v[112:127], v[24:27], v[16:19], v[112:127]
    ds_read_b128 v[72:75], v59 offset:0
    ds_read_b64_tr_b16 v[80:81], v60 offset:43008
    v_rcp_f32 v70, v70
    v_mfma_f32_32x32x16_bf16 v[176:191], v[24:27], v[20:23], v[176:191]
    ds_read_b64_tr_b16 v[82:83], v60 offset:43520
    ds_read_b128 v[76:79], v59 offset:4096
    v_rcp_f32 v71, v71
    v_mul_f32 v196, v196, v68
    v_mul_f32 v197, v197, v69
    v_mfma_f32_32x32x16_bf16 v[144:159], v[28:31], v[16:19], v[144:159]
    ds_read_b64_tr_b16 v[84:85], v60 offset:47104
    ds_read_b64_tr_b16 v[86:87], v60 offset:47616
    v_mul_f32 v198, v198, v70
    v_mul_f32 v199, v199, v71
    v_cvt_pk_bf16_f32 v250, v196, v197
    v_cvt_pk_bf16_f32 v251, v198, v199
    v_mfma_f32_32x32x16_bf16 v[208:223], v[28:31], v[20:23], v[208:223]
    v_add_u32 v59, 0x4000, v59
    v_mul_f32 v64, v168, v168
    v_mul_f32 v65, v169, v169
    v_mul_f32 v66, v170, v170
    v_mul_f32 v67, v171, v171
    v_fma_f32 v64, v64, v10, v12
    s_waitcnt lgkmcnt(6)
    v_mfma_f32_32x32x16_bf16 v[112:127], v[44:47], v[36:39], v[112:127]
    s_barrier
    ds_read_b128 v[16:19], v56 offset:0
    ds_read_b64_tr_b16 v[24:25], v60 offset:0
    v_fma_f32 v65, v65, v10, v12
    v_fma_f32 v66, v66, v10, v12
    v_mfma_f32_32x32x16_bf16 v[176:191], v[44:47], v[40:43], v[176:191]
    ds_read_b64_tr_b16 v[26:27], v60 offset:512
    ds_read_b128 v[20:23], v56 offset:4096
    v_fma_f32 v67, v67, v10, v12
    v_mul_f32 v64, v64, v168
    v_mul_f32 v65, v65, v169
    v_mul_f32 v66, v66, v170
    v_mfma_f32_32x32x16_bf16 v[144:159], v[48:51], v[36:39], v[144:159]
    ds_read_b64_tr_b16 v[28:29], v60 offset:4096
    ds_read_b64_tr_b16 v[30:31], v60 offset:4608
    v_mul_f32 v67, v67, v171
    v_exp_f32 v64, v64
    v_mul_f32 v200, v200, v168
    v_mfma_f32_32x32x16_bf16 v[208:223], v[48:51], v[40:43], v[208:223]
    v_add_u32 v56, 0x4000, v56
    v_exp_f32 v65, v65
    v_mul_f32 v201, v201, v169
    v_exp_f32 v66, v66
    s_waitcnt lgkmcnt(6)
    v_mfma_f32_32x32x16_bf16 v[112:127], v[80:83], v[72:75], v[112:127]
    ds_read_b128 v[36:39], v57 offset:0
    ds_read_b64_tr_b16 v[44:45], v60 offset:2048
    v_mul_f32 v202, v202, v170
    v_exp_f32 v67, v67
    v_mfma_f32_32x32x16_bf16 v[176:191], v[80:83], v[76:79], v[176:191]
    ds_read_b64_tr_b16 v[46:47], v60 offset:2560
    ds_read_b128 v[40:43], v57 offset:4096
    v_mul_f32 v203, v203, v171
    v_add_f32 v64, 1.0, v64
    v_add_f32 v65, 1.0, v65
    v_add_f32 v66, 1.0, v66
    v_mfma_f32_32x32x16_bf16 v[144:159], v[84:87], v[72:75], v[144:159]
    ds_read_b64_tr_b16 v[48:49], v60 offset:6144
    ds_read_b64_tr_b16 v[50:51], v60 offset:6656
    v_add_f32 v67, 1.0, v67
    v_rcp_f32 v64, v64
    v_mfma_f32_32x32x16_bf16 v[208:223], v[84:87], v[76:79], v[208:223]
    v_add_u32 v57, 0x4000, v57
    v_rcp_f32 v65, v65
    v_rcp_f32 v66, v66
    s_waitcnt lgkmcnt(6)
    v_mfma_f32_32x32x16_bf16 v[112:127], v[24:27], v[16:19], v[112:127]
    s_barrier
    ds_read_b128 v[72:75], v58 offset:0
    ds_read_b64_tr_b16 v[80:81], v60 offset:8192
    v_rcp_f32 v67, v67
    v_mfma_f32_32x32x16_bf16 v[176:191], v[24:27], v[20:23], v[176:191]
    ds_read_b64_tr_b16 v[82:83], v60 offset:8704
    ds_read_b128 v[76:79], v58 offset:4096
    v_mul_f32 v200, v200, v64
    v_mul_f32 v201, v201, v65
    v_mul_f32 v202, v202, v66
    v_mul_f32 v203, v203, v67
    v_mfma_f32_32x32x16_bf16 v[144:159], v[28:31], v[16:19], v[144:159]
    ds_read_b64_tr_b16 v[84:85], v60 offset:12288
    ds_read_b64_tr_b16 v[86:87], v60 offset:12800
    v_cvt_pk_bf16_f32 v252, v200, v201
    v_cvt_pk_bf16_f32 v253, v202, v203
    v_mul_f32 v68, v172, v172
    v_mul_f32 v69, v173, v173
    v_mfma_f32_32x32x16_bf16 v[208:223], v[28:31], v[20:23], v[208:223]
    v_add_u32 v58, 0x4000, v58
    v_mul_f32 v70, v174, v174
    v_mul_f32 v71, v175, v175
    v_fma_f32 v68, v68, v10, v12
    v_fma_f32 v69, v69, v10, v12
    v_fma_f32 v70, v70, v10, v12
    s_waitcnt lgkmcnt(6)
    v_mfma_f32_32x32x16_bf16 v[112:127], v[44:47], v[36:39], v[112:127]
    ds_read_b128 v[16:19], v59 offset:0
    ds_read_b64_tr_b16 v[24:25], v60 offset:10240
    v_fma_f32 v71, v71, v10, v12
    v_mul_f32 v68, v68, v172
    v_mul_f32 v69, v69, v173
    v_mfma_f32_32x32x16_bf16 v[176:191], v[44:47], v[40:43], v[176:191]
    ds_read_b64_tr_b16 v[26:27], v60 offset:10752
    ds_read_b128 v[20:23], v59 offset:4096
    v_mul_f32 v70, v70, v174
    v_mul_f32 v71, v71, v175
    v_exp_f32 v68, v68
    v_mfma_f32_32x32x16_bf16 v[144:159], v[48:51], v[36:39], v[144:159]
    ds_read_b64_tr_b16 v[28:29], v60 offset:14336
    ds_read_b64_tr_b16 v[30:31], v60 offset:14848
    v_mul_f32 v204, v204, v172
    v_exp_f32 v69, v69
    v_mul_f32 v205, v205, v173
    v_mfma_f32_32x32x16_bf16 v[208:223], v[48:51], v[40:43], v[208:223]
    v_add_u32 v59, 0x4000, v59
    v_exp_f32 v70, v70
    v_mul_f32 v206, v206, v174
    v_exp_f32 v71, v71
    s_waitcnt lgkmcnt(6)
    v_mfma_f32_32x32x16_bf16 v[112:127], v[80:83], v[72:75], v[112:127]
    ds_read_b128 v[36:39], v56 offset:0
    ds_read_b64_tr_b16 v[44:45], v60 offset:16384
    v_mul_f32 v207, v207, v175
    v_add_f32 v68, 1.0, v68
    v_add_f32 v69, 1.0, v69
    v_mfma_f32_32x32x16_bf16 v[176:191], v[80:83], v[76:79], v[176:191]
    ds_read_b64_tr_b16 v[46:47], v60 offset:16896
    ds_read_b128 v[40:43], v56 offset:4096
    v_add_f32 v70, 1.0, v70
    v_add_f32 v71, 1.0, v71
    v_rcp_f32 v68, v68
    v_mfma_f32_32x32x16_bf16 v[144:159], v[84:87], v[72:75], v[144:159]
    ds_read_b64_tr_b16 v[48:49], v60 offset:20480
    ds_read_b64_tr_b16 v[50:51], v60 offset:20992
    v_rcp_f32 v69, v69
    v_rcp_f32 v70, v70
    v_mfma_f32_32x32x16_bf16 v[208:223], v[84:87], v[76:79], v[208:223]
    v_rcp_f32 v71, v71
    v_mul_f32 v204, v204, v68
    v_mul_f32 v205, v205, v69
    v_mul_f32 v206, v206, v70
    v_mul_f32 v207, v207, v71
    s_waitcnt lgkmcnt(6)
    v_mfma_f32_32x32x16_bf16 v[112:127], v[24:27], v[16:19], v[112:127]
    ds_read_b128 v[72:75], v57 offset:0
    ds_read_b64_tr_b16 v[80:81], v60 offset:18432
    v_cvt_pk_bf16_f32 v254, v204, v205
    v_cvt_pk_bf16_f32 v255, v206, v207
    v_mfma_f32_32x32x16_bf16 v[176:191], v[24:27], v[20:23], v[176:191]
    ds_read_b64_tr_b16 v[82:83], v60 offset:18944
    ds_read_b128 v[76:79], v57 offset:4096
    v_mfma_f32_32x32x16_bf16 v[144:159], v[28:31], v[16:19], v[144:159]
    ds_read_b64_tr_b16 v[84:85], v60 offset:22528
    ds_read_b64_tr_b16 v[86:87], v60 offset:23040
    v_mfma_f32_32x32x16_bf16 v[208:223], v[28:31], v[20:23], v[208:223]
    s_waitcnt lgkmcnt(6)
    v_mfma_f32_32x32x16_bf16 v[112:127], v[44:47], v[36:39], v[112:127]
    ds_read_b128 v[16:19], v58 offset:0
    ds_read_b64_tr_b16 v[24:25], v60 offset:24576
    v_mfma_f32_32x32x16_bf16 v[176:191], v[44:47], v[40:43], v[176:191]
    ds_read_b64_tr_b16 v[26:27], v60 offset:25088
    ds_read_b128 v[20:23], v58 offset:4096
    v_mfma_f32_32x32x16_bf16 v[144:159], v[48:51], v[36:39], v[144:159]
    ds_read_b64_tr_b16 v[28:29], v60 offset:28672
    ds_read_b64_tr_b16 v[30:31], v60 offset:29184
    v_mfma_f32_32x32x16_bf16 v[208:223], v[48:51], v[40:43], v[208:223]
    s_waitcnt lgkmcnt(6)
    v_mfma_f32_32x32x16_bf16 v[112:127], v[80:83], v[72:75], v[112:127]
    ds_read_b128 v[36:39], v59 offset:0
    ds_read_b64_tr_b16 v[44:45], v60 offset:26624
    v_mfma_f32_32x32x16_bf16 v[176:191], v[80:83], v[76:79], v[176:191]
    ds_read_b64_tr_b16 v[46:47], v60 offset:27136
    ds_read_b128 v[40:43], v59 offset:4096
    v_mfma_f32_32x32x16_bf16 v[144:159], v[84:87], v[72:75], v[144:159]
    ds_read_b64_tr_b16 v[48:49], v60 offset:30720
    ds_read_b64_tr_b16 v[50:51], v60 offset:31232
    v_mfma_f32_32x32x16_bf16 v[208:223], v[84:87], v[76:79], v[208:223]
    s_waitcnt lgkmcnt(6)
    v_mfma_f32_32x32x16_bf16 v[112:127], v[24:27], v[16:19], v[112:127]
    v_mfma_f32_32x32x16_bf16 v[176:191], v[24:27], v[20:23], v[176:191]
    v_mfma_f32_32x32x16_bf16 v[144:159], v[28:31], v[16:19], v[144:159]
    v_mfma_f32_32x32x16_bf16 v[208:223], v[28:31], v[20:23], v[208:223]
    s_waitcnt lgkmcnt(0)
    v_mfma_f32_32x32x16_bf16 v[112:127], v[44:47], v[36:39], v[112:127]
    v_mfma_f32_32x32x16_bf16 v[176:191], v[44:47], v[40:43], v[176:191]
    v_mfma_f32_32x32x16_bf16 v[144:159], v[48:51], v[36:39], v[144:159]
    v_mfma_f32_32x32x16_bf16 v[208:223], v[48:51], v[40:43], v[208:223]
    s_branch L_p2done
L_p1loopV:
    s_waitcnt lgkmcnt(5)
    v_mfma_f32_32x32x16_bf16 v[96:111], v[16:19], v[24:27], v[96:111]
    ds_read_b128 v[36:39], v57 offset:0
    ds_read_b64_tr_b16 v[44:45], v60 offset:2048
    s_waitcnt lgkmcnt(6)
    v_mfma_f32_32x32x16_bf16 v[160:175], v[20:23], v[24:27], v[160:175]
    ds_read_b64_tr_b16 v[46:47], v60 offset:2560
    ds_read_b128 v[40:43], v57 offset:4096
    s_waitcnt lgkmcnt(6)
    v_mfma_f32_32x32x16_bf16 v[128:143], v[16:19], v[28:31], v[128:143]
    ds_read_b64_tr_b16 v[48:49], v60 offset:6144
    ds_read_b64_tr_b16 v[50:51], v60 offset:6656
    v_mfma_f32_32x32x16_bf16 v[192:207], v[20:23], v[28:31], v[192:207]
    ds_read_b64_tr_b16 v[52:53], v60 offset:10240
    ds_read_b64_tr_b16 v[54:55], v60 offset:10752
    s_add_u32 s46, s46, 1
    s_cmp_eq_u32 s46, 5
    s_cselect_b32 s49, s51, 12288
    s_cselect_b32 s46, 0, s46
    v_add_u32 v60, s49, v60
    s_waitcnt lgkmcnt(8)
    v_mfma_f32_32x32x16_bf16 v[224:239], v[32:35], v[16:19], v[224:239]
    v_mfma_f32_32x32x16_bf16 v[240:255], v[32:35], v[20:23], v[240:255]
    s_waitcnt lgkmcnt(5)
    v_mfma_f32_32x32x16_bf16 v[96:111], v[36:39], v[44:47], v[96:111]
    s_waitcnt lgkmcnt(4)
    v_mfma_f32_32x32x16_bf16 v[160:175], v[40:43], v[44:47], v[160:175]
    s_waitcnt lgkmcnt(0)
    v_mfma_f32_32x32x16_bf16 v[128:143], v[36:39], v[48:51], v[128:143]
    s_barrier
    ds_read_b128 v[16:19], v58 offset:0
    ds_read_b64_tr_b16 v[24:25], v60 offset:0
    v_mfma_f32_32x32x16_bf16 v[192:207], v[40:43], v[48:51], v[192:207]
    ds_read_b64_tr_b16 v[26:27], v60 offset:512
    ds_read_b128 v[20:23], v58 offset:4096
    v_mfma_f32_32x32x16_bf16 v[224:239], v[52:55], v[36:39], v[224:239]
    ds_read_b64_tr_b16 v[28:29], v60 offset:4096
    ds_read_b64_tr_b16 v[30:31], v60 offset:4608
    v_mfma_f32_32x32x16_bf16 v[240:255], v[52:55], v[40:43], v[240:255]
    ds_read_b64_tr_b16 v[32:33], v60 offset:8192
    ds_read_b64_tr_b16 v[34:35], v60 offset:8704
    s_waitcnt lgkmcnt(5)
    v_mfma_f32_32x32x16_bf16 v[96:111], v[16:19], v[24:27], v[96:111]
    ds_read_b128 v[36:39], v59 offset:0
    ds_read_b64_tr_b16 v[44:45], v60 offset:2048
    s_waitcnt lgkmcnt(6)
    v_mfma_f32_32x32x16_bf16 v[160:175], v[20:23], v[24:27], v[160:175]
    ds_read_b64_tr_b16 v[46:47], v60 offset:2560
    ds_read_b128 v[40:43], v59 offset:4096
    s_waitcnt lgkmcnt(6)
    v_mfma_f32_32x32x16_bf16 v[128:143], v[16:19], v[28:31], v[128:143]
    ds_read_b64_tr_b16 v[48:49], v60 offset:6144
    ds_read_b64_tr_b16 v[50:51], v60 offset:6656
    v_mfma_f32_32x32x16_bf16 v[192:207], v[20:23], v[28:31], v[192:207]
    ds_read_b64_tr_b16 v[52:53], v60 offset:10240
    ds_read_b64_tr_b16 v[54:55], v60 offset:10752
    s_add_u32 s46, s46, 1
    s_cmp_eq_u32 s46, 5
    s_cselect_b32 s49, s51, 12288
    s_cselect_b32 s46, 0, s46
    v_add_u32 v60, s49, v60
    s_waitcnt lgkmcnt(8)
    v_mfma_f32_32x32x16_bf16 v[224:239], v[32:35], v[16:19], v[224:239]
    s_add_u32 s47, s47, 1
    s_cmp_eq_u32 s47, 6
    s_cselect_b32 s50, s52, 16384
    s_cselect_b32 s47, 0, s47
    v_add_u32 v56, s50, v56
    v_mfma_f32_32x32x16_bf16 v[240:255], v[32:35], v[20:23], v[240:255]
    s_waitcnt lgkmcnt(5)
    v_mfma_f32_32x32x16_bf16 v[96:111], v[36:39], v[44:47], v[96:111]
    v_add_u32 v57, s50, v57
    v_add_u32 v58, s50, v58
    v_add_u32 v59, s50, v59
    s_waitcnt lgkmcnt(4)
    v_mfma_f32_32x32x16_bf16 v[160:175], v[40:43], v[44:47], v[160:175]
    s_sub_u32 s48, s48, 1
    s_cmp_lg_u32 s48, 0
    s_waitcnt lgkmcnt(0)
    v_mfma_f32_32x32x16_bf16 v[128:143], v[36:39], v[48:51], v[128:143]
    s_barrier
    ds_read_b128 v[16:19], v56 offset:0
    ds_read_b64_tr_b16 v[24:25], v60 offset:0
    v_mfma_f32_32x32x16_bf16 v[192:207], v[40:43], v[48:51], v[192:207]
    ds_read_b64_tr_b16 v[26:27], v60 offset:512
    ds_read_b128 v[20:23], v56 offset:4096
    v_mfma_f32_32x32x16_bf16 v[224:239], v[52:55], v[36:39], v[224:239]
    ds_read_b64_tr_b16 v[28:29], v60 offset:4096
    ds_read_b64_tr_b16 v[30:31], v60 offset:4608
    v_mfma_f32_32x32x16_bf16 v[240:255], v[52:55], v[40:43], v[240:255]
    ds_read_b64_tr_b16 v[32:33], v60 offset:8192
    ds_read_b64_tr_b16 v[34:35], v60 offset:8704
    s_cbranch_scc1 L_p1loopV
    v_add_u32 v56, 0x4000, v56
    ds_read_b128 v[36:39], v57 offset:0
    ds_read_b64_tr_b16 v[44:45], v60 offset:2048
    ds_read_b64_tr_b16 v[46:47], v60 offset:2560
    ds_read_b128 v[40:43], v57 offset:4096
    ds_read_b64_tr_b16 v[48:49], v60 offset:6144
    ds_read_b64_tr_b16 v[50:51], v60 offset:6656
    v_add_u32 v57, 0x4000, v57
    s_waitcnt lgkmcnt(8)
    v_mfma_f32_32x32x16_bf16 v[112:127], v[24:27], v[16:19], v[112:127]
    s_barrier
    ds_read_b128 v[72:75], v58 offset:0
    ds_read_b64_tr_b16 v[80:81], v60 offset:8192
    v_mfma_f32_32x32x16_bf16 v[176:191], v[24:27], v[20:23], v[176:191]
    ds_read_b64_tr_b16 v[82:83], v60 offset:8704
    ds_read_b128 v[76:79], v58 offset:4096
    v_mfma_f32_32x32x16_bf16 v[144:159], v[28:31], v[16:19], v[144:159]
    ds_read_b64_tr_b16 v[84:85], v60 offset:12288
    ds_read_b64_tr_b16 v[86:87], v60 offset:12800
    v_mfma_f32_32x32x16_bf16 v[208:223], v[28:31], v[20:23], v[208:223]
    v_add_u32 v58, 0x4000, v58
    s_waitcnt lgkmcnt(6)
    v_mfma_f32_32x32x16_bf16 v[112:127], v[44:47], v[36:39], v[112:127]
    ds_read_b128 v[16:19], v59 offset:0
    ds_read_b64_tr_b16 v[24:25], v60 offset:10240
    v_cvt_pk_bf16_f32 v96, v96, v97
    v_cvt_pk_bf16_f32 v97, v98, v99
    v_cvt_pk_bf16_f32 v98, v100, v101
    v_mfma_f32_32x32x16_bf16 v[176:191], v[44:47], v[40:43], v[176:191]
    ds_read_b64_tr_b16 v[26:27], v60 offset:10752
    ds_read_b128 v[20:23], v59 offset:4096
    v_cvt_pk_bf16_f32 v99, v102, v103
    buffer_store_dwordx4 v[96:99], v9, s[28:31], s44 offen offset:0 sc1
    v_cvt_pk_bf16_f32 v104, v104, v105
    v_cvt_pk_bf16_f32 v105, v106, v107
    v_mfma_f32_32x32x16_bf16 v[144:159], v[48:51], v[36:39], v[144:159]
    ds_read_b64_tr_b16 v[28:29], v60 offset:14336
    ds_read_b64_tr_b16 v[30:31], v60 offset:14848
    v_cvt_pk_bf16_f32 v106, v108, v109
    v_cvt_pk_bf16_f32 v107, v110, v111
    buffer_store_dwordx4 v[104:107], v9, s[28:31], s44 offen offset:512 sc1
    v_cvt_pk_bf16_f32 v160, v160, v161
    v_mfma_f32_32x32x16_bf16 v[208:223], v[48:51], v[40:43], v[208:223]
    v_add_u32 v59, 0x4000, v59
    v_cvt_pk_bf16_f32 v161, v162, v163
    v_cvt_pk_bf16_f32 v162, v164, v165
    v_cvt_pk_bf16_f32 v163, v166, v167
    buffer_store_dwordx4 v[160:163], v9, s[28:31], s44 offen offset:1024 sc1
    v_cvt_pk_bf16_f32 v168, v168, v169
    s_waitcnt lgkmcnt(6)
    v_mfma_f32_32x32x16_bf16 v[112:127], v[80:83], v[72:75], v[112:127]
    s_barrier
    ds_read_b128 v[36:39], v56 offset:0
    ds_read_b64_tr_b16 v[44:45], v60 offset:16384
    v_cvt_pk_bf16_f32 v169, v170, v171
    v_cvt_pk_bf16_f32 v170, v172, v173
    v_mfma_f32_32x32x16_bf16 v[176:191], v[80:83], v[76:79], v[176:191]
    ds_read_b64_tr_b16 v[46:47], v60 offset:16896
    ds_read_b128 v[40:43], v56 offset:4096
    v_cvt_pk_bf16_f32 v171, v174, v175
    buffer_store_dwordx4 v[168:171], v9, s[28:31], s44 offen offset:1536 sc1
    v_cvt_pk_bf16_f32 v128, v128, v129
    v_cvt_pk_bf16_f32 v129, v130, v131
    v_mfma_f32_32x32x16_bf16 v[144:159], v[84:87], v[72:75], v[144:159]
    ds_read_b64_tr_b16 v[48:49], v60 offset:20480
    ds_read_b64_tr_b16 v[50:51], v60 offset:20992
    v_cvt_pk_bf16_f32 v130, v132, v133
    v_cvt_pk_bf16_f32 v131, v134, v135
    buffer_store_dwordx4 v[128:131], v9, s[28:31], s45 offen offset:0 sc1
    v_cvt_pk_bf16_f32 v136, v136, v137
    v_mfma_f32_32x32x16_bf16 v[208:223], v[84:87], v[76:79], v[208:223]
    v_add_u32 v56, 0x4000, v56
    v_cvt_pk_bf16_f32 v137, v138, v139
    v_cvt_pk_bf16_f32 v138, v140, v141
    v_cvt_pk_bf16_f32 v139, v142, v143
    buffer_store_dwordx4 v[136:139], v9, s[28:31], s45 offen offset:512 sc1
    v_cvt_pk_bf16_f32 v192, v192, v193
    s_waitcnt lgkmcnt(6)
    v_mfma_f32_32x32x16_bf16 v[112:127], v[24:27], v[16:19], v[112:127]
    ds_read_b128 v[72:75], v57 offset:0
    ds_read_b64_tr_b16 v[80:81], v60 offset:18432
    v_cvt_pk_bf16_f32 v193, v194, v195
    v_cvt_pk_bf16_f32 v194, v196, v197
    v_cvt_pk_bf16_f32 v195, v198, v199
    v_mfma_f32_32x32x16_bf16 v[176:191], v[24:27], v[20:23], v[176:191]
    ds_read_b64_tr_b16 v[82:83], v60 offset:18944
    ds_read_b128 v[76:79], v57 offset:4096
    buffer_store_dwordx4 v[192:195], v9, s[28:31], s45 offen offset:1024 sc1
    v_cvt_pk_bf16_f32 v200, v200, v201
    v_cvt_pk_bf16_f32 v201, v202, v203
    v_cvt_pk_bf16_f32 v202, v204, v205
    v_mfma_f32_32x32x16_bf16 v[144:159], v[28:31], v[16:19], v[144:159]
    ds_read_b64_tr_b16 v[84:85], v60 offset:22528
    ds_read_b64_tr_b16 v[86:87], v60 offset:23040
    v_cvt_pk_bf16_f32 v203, v206, v207
    buffer_store_dwordx4 v[200:203], v9, s[28:31], s45 offen offset:1536 sc1
    v_mul_f32 v224, s53, v224
    v_mul_f32 v225, s53, v225
    v_mfma_f32_32x32x16_bf16 v[208:223], v[28:31], v[20:23], v[208:223]
    v_add_u32 v57, 0x4000, v57
    v_mul_f32 v226, s53, v226
    v_mul_f32 v227, s53, v227
    v_mul_f32 v228, s53, v228
    v_mul_f32 v229, s53, v229
    v_mul_f32 v230, s53, v230
    s_waitcnt lgkmcnt(6)
    v_mfma_f32_32x32x16_bf16 v[112:127], v[44:47], v[36:39], v[112:127]
    s_barrier
    ds_read_b128 v[16:19], v58 offset:0
    ds_read_b64_tr_b16 v[24:25], v60 offset:24576
    v_mul_f32 v231, s53, v231
    v_cvt_pk_bf16_f32 v224, v224, v225
    v_mfma_f32_32x32x16_bf16 v[176:191], v[44:47], v[40:43], v[176:191]
    ds_read_b64_tr_b16 v[26:27], v60 offset:25088
    ds_read_b128 v[20:23], v58 offset:4096
    v_cvt_pk_bf16_f32 v225, v226, v227
    v_cvt_pk_bf16_f32 v226, v228, v229
    v_cvt_pk_bf16_f32 v227, v230, v231
    buffer_store_dwordx4 v[224:227], v3, s[28:31], s54 offen offset:0 sc1
    v_mfma_f32_32x32x16_bf16 v[144:159], v[48:51], v[36:39], v[144:159]
    ds_read_b64_tr_b16 v[28:29], v60 offset:28672
    ds_read_b64_tr_b16 v[30:31], v60 offset:29184
    v_mul_f32 v232, s53, v232
    v_mul_f32 v233, s53, v233
    v_mul_f32 v234, s53, v234
    v_mul_f32 v235, s53, v235
    v_mfma_f32_32x32x16_bf16 v[208:223], v[48:51], v[40:43], v[208:223]
    v_add_u32 v58, 0x4000, v58
    v_mul_f32 v236, s53, v236
    v_mul_f32 v237, s53, v237
    v_mul_f32 v238, s53, v238
    v_mul_f32 v239, s53, v239
    v_cvt_pk_bf16_f32 v232, v232, v233
    s_waitcnt lgkmcnt(6)
    v_mfma_f32_32x32x16_bf16 v[112:127], v[80:83], v[72:75], v[112:127]
    ds_read_b128 v[36:39], v59 offset:0
    ds_read_b64_tr_b16 v[44:45], v60 offset:26624
    v_cvt_pk_bf16_f32 v233, v234, v235
    v_cvt_pk_bf16_f32 v234, v236, v237
    v_cvt_pk_bf16_f32 v235, v238, v239
    v_mfma_f32_32x32x16_bf16 v[176:191], v[80:83], v[76:79], v[176:191]
    ds_read_b64_tr_b16 v[46:47], v60 offset:27136
    ds_read_b128 v[40:43], v59 offset:4096
    buffer_store_dwordx4 v[232:235], v3, s[28:31], s55 offen offset:0 sc1
    v_mul_f32 v240, s53, v240
    v_mul_f32 v241, s53, v241
    v_mul_f32 v242, s53, v242
    v_mfma_f32_32x32x16_bf16 v[144:159], v[84:87], v[72:75], v[144:159]
    ds_read_b64_tr_b16 v[48:49], v60 offset:30720
    ds_read_b64_tr_b16 v[50:51], v60 offset:31232
    v_mul_f32 v243, s53, v243
    v_mul_f32 v244, s53, v244
    v_mul_f32 v245, s53, v245
    v_mul_f32 v246, s53, v246
    v_mfma_f32_32x32x16_bf16 v[208:223], v[84:87], v[76:79], v[208:223]
    v_add_u32 v59, 0x4000, v59
    v_mul_f32 v247, s53, v247
    v_cvt_pk_bf16_f32 v240, v240, v241
    v_cvt_pk_bf16_f32 v241, v242, v243
    v_cvt_pk_bf16_f32 v242, v244, v245
    v_cvt_pk_bf16_f32 v243, v246, v247
    s_waitcnt lgkmcnt(6)
    v_mfma_f32_32x32x16_bf16 v[112:127], v[24:27], v[16:19], v[112:127]
    s_barrier
    ds_read_b128 v[72:75], v56 offset:0
    ds_read_b64_tr_b16 v[80:81], v60 offset:32768
    buffer_store_dwordx4 v[240:243], v3, s[28:31], s54 offen offset:1024 sc1
    v_mul_f32 v248, s53, v248
    v_mfma_f32_32x32x16_bf16 v[176:191], v[24:27], v[20:23], v[176:191]
    ds_read_b64_tr_b16 v[82:83], v60 offset:33280
    ds_read_b128 v[76:79], v56 offset:4096
    v_mul_f32 v249, s53, v249
    v_mul_f32 v250, s53, v250
    v_mul_f32 v251, s53, v251
    v_mul_f32 v252, s53, v252
    v_mfma_f32_32x32x16_bf16 v[144:159], v[28:31], v[16:19], v[144:159]
    ds_read_b64_tr_b16 v[84:85], v60 offset:36864
    ds_read_b64_tr_b16 v[86:87], v60 offset:37376
    v_mul_f32 v253, s53, v253
    v_mul_f32 v254, s53, v254
    v_mul_f32 v255, s53, v255
    v_cvt_pk_bf16_f32 v248, v248, v249
    v_mfma_f32_32x32x16_bf16 v[208:223], v[28:31], v[20:23], v[208:223]
    v_add_u32 v56, 0x4000, v56
    v_cvt_pk_bf16_f32 v249, v250, v251
    v_cvt_pk_bf16_f32 v250, v252, v253
    v_cvt_pk_bf16_f32 v251, v254, v255
    buffer_store_dwordx4 v[248:251], v3, s[28:31], s55 offen offset:1024 sc1
    s_waitcnt lgkmcnt(6)
    v_mfma_f32_32x32x16_bf16 v[112:127], v[44:47], v[36:39], v[112:127]
    ds_read_b128 v[16:19], v57 offset:0
    ds_read_b64_tr_b16 v[24:25], v60 offset:34816
    v_mfma_f32_32x32x16_bf16 v[176:191], v[44:47], v[40:43], v[176:191]
    ds_read_b64_tr_b16 v[26:27], v60 offset:35328
    ds_read_b128 v[20:23], v57 offset:4096
    v_mfma_f32_32x32x16_bf16 v[144:159], v[48:51], v[36:39], v[144:159]
    ds_read_b64_tr_b16 v[28:29], v60 offset:38912
    ds_read_b64_tr_b16 v[30:31], v60 offset:39424
    v_mfma_f32_32x32x16_bf16 v[208:223], v[48:51], v[40:43], v[208:223]
    v_add_u32 v57, 0x4000, v57
    s_waitcnt lgkmcnt(6)
    v_mfma_f32_32x32x16_bf16 v[112:127], v[80:83], v[72:75], v[112:127]
    s_barrier
    ds_read_b128 v[36:39], v58 offset:0
    ds_read_b64_tr_b16 v[44:45], v60 offset:40960
    v_mfma_f32_32x32x16_bf16 v[176:191], v[80:83], v[76:79], v[176:191]
    ds_read_b64_tr_b16 v[46:47], v60 offset:41472
    ds_read_b128 v[40:43], v58 offset:4096
    v_mfma_f32_32x32x16_bf16 v[144:159], v[84:87], v[72:75], v[144:159]
    ds_read_b64_tr_b16 v[48:49], v60 offset:45056
    ds_read_b64_tr_b16 v[50:51], v60 offset:45568
    v_mfma_f32_32x32x16_bf16 v[208:223], v[84:87], v[76:79], v[208:223]
    v_add_u32 v58, 0x4000, v58
    s_waitcnt lgkmcnt(6)
    v_mfma_f32_32x32x16_bf16 v[112:127], v[24:27], v[16:19], v[112:127]
    ds_read_b128 v[72:75], v59 offset:0
    ds_read_b64_tr_b16 v[80:81], v60 offset:43008
    v_mfma_f32_32x32x16_bf16 v[176:191], v[24:27], v[20:23], v[176:191]
    ds_read_b64_tr_b16 v[82:83], v60 offset:43520
    ds_read_b128 v[76:79], v59 offset:4096
    v_mfma_f32_32x32x16_bf16 v[144:159], v[28:31], v[16:19], v[144:159]
    ds_read_b64_tr_b16 v[84:85], v60 offset:47104
    ds_read_b64_tr_b16 v[86:87], v60 offset:47616
    v_mfma_f32_32x32x16_bf16 v[208:223], v[28:31], v[20:23], v[208:223]
    v_add_u32 v59, 0x4000, v59
    s_waitcnt lgkmcnt(6)
    v_mfma_f32_32x32x16_bf16 v[112:127], v[44:47], v[36:39], v[112:127]
    s_waitcnt vmcnt(0)
    s_barrier
    ds_read_b128 v[16:19], v56 offset:0
    ds_read_b64_tr_b16 v[24:25], v60 offset:0
    v_mfma_f32_32x32x16_bf16 v[176:191], v[44:47], v[40:43], v[176:191]
    ds_read_b64_tr_b16 v[26:27], v60 offset:512
    ds_read_b128 v[20:23], v56 offset:4096
    v_mfma_f32_32x32x16_bf16 v[144:159], v[48:51], v[36:39], v[144:159]
    ds_read_b64_tr_b16 v[28:29], v60 offset:4096
    ds_read_b64_tr_b16 v[30:31], v60 offset:4608
    v_mfma_f32_32x32x16_bf16 v[208:223], v[48:51], v[40:43], v[208:223]
    v_add_u32 v56, 0xfffec000, v56
    s_waitcnt lgkmcnt(6)
    v_mfma_f32_32x32x16_bf16 v[112:127], v[80:83], v[72:75], v[112:127]
    ds_read_b128 v[36:39], v57 offset:0
    ds_read_b64_tr_b16 v[44:45], v60 offset:2048
    v_mfma_f32_32x32x16_bf16 v[176:191], v[80:83], v[76:79], v[176:191]
    ds_read_b64_tr_b16 v[46:47], v60 offset:2560
    ds_read_b128 v[40:43], v57 offset:4096
    v_mfma_f32_32x32x16_bf16 v[144:159], v[84:87], v[72:75], v[144:159]
    ds_read_b64_tr_b16 v[48:49], v60 offset:6144
    ds_read_b64_tr_b16 v[50:51], v60 offset:6656
    v_mfma_f32_32x32x16_bf16 v[208:223], v[84:87], v[76:79], v[208:223]
    v_add_u32 v57, 0xfffec000, v57
    s_waitcnt lgkmcnt(6)
    v_mfma_f32_32x32x16_bf16 v[112:127], v[24:27], v[16:19], v[112:127]
    s_barrier
    ds_read_b128 v[72:75], v58 offset:0
    ds_read_b64_tr_b16 v[80:81], v60 offset:8192
    v_mfma_f32_32x32x16_bf16 v[176:191], v[24:27], v[20:23], v[176:191]
    ds_read_b64_tr_b16 v[82:83], v60 offset:8704
    ds_read_b128 v[76:79], v58 offset:4096
    v_mfma_f32_32x32x16_bf16 v[144:159], v[28:31], v[16:19], v[144:159]
    ds_read_b64_tr_b16 v[84:85], v60 offset:12288
    ds_read_b64_tr_b16 v[86:87], v60 offset:12800
    v_mfma_f32_32x32x16_bf16 v[208:223], v[28:31], v[20:23], v[208:223]
    v_add_u32 v58, 0xfffec000, v58
    s_waitcnt lgkmcnt(6)
    v_mfma_f32_32x32x16_bf16 v[112:127], v[44:47], v[36:39], v[112:127]
    ds_read_b128 v[16:19], v59 offset:0
    ds_read_b64_tr_b16 v[24:25], v60 offset:10240
    v_mfma_f32_32x32x16_bf16 v[176:191], v[44:47], v[40:43], v[176:191]
    ds_read_b64_tr_b16 v[26:27], v60 offset:10752
    ds_read_b128 v[20:23], v59 offset:4096
    v_mfma_f32_32x32x16_bf16 v[144:159], v[48:51], v[36:39], v[144:159]
    ds_read_b64_tr_b16 v[28:29], v60 offset:14336
    ds_read_b64_tr_b16 v[30:31], v60 offset:14848
    v_mfma_f32_32x32x16_bf16 v[208:223], v[48:51], v[40:43], v[208:223]
    v_add_u32 v59, 0xfffec000, v59
    s_waitcnt lgkmcnt(6)
    v_mfma_f32_32x32x16_bf16 v[112:127], v[80:83], v[72:75], v[112:127]
    s_barrier
    ds_read_b128 v[36:39], v56 offset:0
    ds_read_b64_tr_b16 v[44:45], v60 offset:16384
    v_mfma_f32_32x32x16_bf16 v[176:191], v[80:83], v[76:79], v[176:191]
    ds_read_b64_tr_b16 v[46:47], v60 offset:16896
    ds_read_b128 v[40:43], v56 offset:4096
    v_mfma_f32_32x32x16_bf16 v[144:159], v[84:87], v[72:75], v[144:159]
    ds_read_b64_tr_b16 v[48:49], v60 offset:20480
    ds_read_b64_tr_b16 v[50:51], v60 offset:20992
    v_mfma_f32_32x32x16_bf16 v[208:223], v[84:87], v[76:79], v[208:223]
    v_add_u32 v56, 0x4000, v56
    s_waitcnt lgkmcnt(6)
    v_mfma_f32_32x32x16_bf16 v[112:127], v[24:27], v[16:19], v[112:127]
    ds_read_b128 v[72:75], v57 offset:0
    ds_read_b64_tr_b16 v[80:81], v60 offset:18432
    v_mfma_f32_32x32x16_bf16 v[176:191], v[24:27], v[20:23], v[176:191]
    ds_read_b64_tr_b16 v[82:83], v60 offset:18944
    ds_read_b128 v[76:79], v57 offset:4096
    v_mfma_f32_32x32x16_bf16 v[144:159], v[28:31], v[16:19], v[144:159]
    ds_read_b64_tr_b16 v[84:85], v60 offset:22528
    ds_read_b64_tr_b16 v[86:87], v60 offset:23040
    v_mfma_f32_32x32x16_bf16 v[208:223], v[28:31], v[20:23], v[208:223]
    v_add_u32 v57, 0x4000, v57
    s_waitcnt lgkmcnt(6)
    v_mfma_f32_32x32x16_bf16 v[112:127], v[44:47], v[36:39], v[112:127]
    s_barrier
    ds_read_b128 v[16:19], v58 offset:0
    ds_read_b64_tr_b16 v[24:25], v60 offset:24576
    v_mfma_f32_32x32x16_bf16 v[176:191], v[44:47], v[40:43], v[176:191]
    ds_read_b64_tr_b16 v[26:27], v60 offset:25088
    ds_read_b128 v[20:23], v58 offset:4096
    v_mfma_f32_32x32x16_bf16 v[144:159], v[48:51], v[36:39], v[144:159]
    ds_read_b64_tr_b16 v[28:29], v60 offset:28672
    ds_read_b64_tr_b16 v[30:31], v60 offset:29184
    v_mfma_f32_32x32x16_bf16 v[208:223], v[48:51], v[40:43], v[208:223]
    v_add_u32 v58, 0x4000, v58
    s_waitcnt lgkmcnt(6)
    v_mfma_f32_32x32x16_bf16 v[112:127], v[80:83], v[72:75], v[112:127]
    ds_read_b128 v[36:39], v59 offset:0
    ds_read_b64_tr_b16 v[44:45], v60 offset:26624
    v_mfma_f32_32x32x16_bf16 v[176:191], v[80:83], v[76:79], v[176:191]
    ds_read_b64_tr_b16 v[46:47], v60 offset:27136
    ds_read_b128 v[40:43], v59 offset:4096
    v_mfma_f32_32x32x16_bf16 v[144:159], v[84:87], v[72:75], v[144:159]
    ds_read_b64_tr_b16 v[48:49], v60 offset:30720
    ds_read_b64_tr_b16 v[50:51], v60 offset:31232
    v_mfma_f32_32x32x16_bf16 v[208:223], v[84:87], v[76:79], v[208:223]
    v_add_u32 v59, 0x4000, v59
    s_waitcnt lgkmcnt(6)
    v_mfma_f32_32x32x16_bf16 v[112:127], v[24:27], v[16:19], v[112:127]
    s_barrier
    ds_read_b128 v[72:75], v56 offset:0
    ds_read_b64_tr_b16 v[80:81], v60 offset:32768
    v_mfma_f32_32x32x16_bf16 v[176:191], v[24:27], v[20:23], v[176:191]
    ds_read_b64_tr_b16 v[82:83], v60 offset:33280
    ds_read_b128 v[76:79], v56 offset:4096
    v_mfma_f32_32x32x16_bf16 v[144:159], v[28:31], v[16:19], v[144:159]
    ds_read_b64_tr_b16 v[84:85], v60 offset:36864
    ds_read_b64_tr_b16 v[86:87], v60 offset:37376
    v_mfma_f32_32x32x16_bf16 v[208:223], v[28:31], v[20:23], v[208:223]
    v_add_u32 v56, 0x4000, v56
    s_waitcnt lgkmcnt(6)
    v_mfma_f32_32x32x16_bf16 v[112:127], v[44:47], v[36:39], v[112:127]
    ds_read_b128 v[16:19], v57 offset:0
    ds_read_b64_tr_b16 v[24:25], v60 offset:34816
    v_mfma_f32_32x32x16_bf16 v[176:191], v[44:47], v[40:43], v[176:191]
    ds_read_b64_tr_b16 v[26:27], v60 offset:35328
    ds_read_b128 v[20:23], v57 offset:4096
    v_mfma_f32_32x32x16_bf16 v[144:159], v[48:51], v[36:39], v[144:159]
    ds_read_b64_tr_b16 v[28:29], v60 offset:38912
    ds_read_b64_tr_b16 v[30:31], v60 offset:39424
    v_mfma_f32_32x32x16_bf16 v[208:223], v[48:51], v[40:43], v[208:223]
    v_add_u32 v57, 0x4000, v57
    s_waitcnt lgkmcnt(6)
    v_mfma_f32_32x32x16_bf16 v[112:127], v[80:83], v[72:75], v[112:127]
    s_barrier
    ds_read_b128 v[36:39], v58 offset:0
    ds_read_b64_tr_b16 v[44:45], v60 offset:40960
    v_mfma_f32_32x32x16_bf16 v[176:191], v[80:83], v[76:79], v[176:191]
    ds_read_b64_tr_b16 v[46:47], v60 offset:41472
    ds_read_b128 v[40:43], v58 offset:4096
    v_mfma_f32_32x32x16_bf16 v[144:159], v[84:87], v[72:75], v[144:159]
    ds_read_b64_tr_b16 v[48:49], v60 offset:45056
    ds_read_b64_tr_b16 v[50:51], v60 offset:45568
    v_mfma_f32_32x32x16_bf16 v[208:223], v[84:87], v[76:79], v[208:223]
    v_add_u32 v58, 0x4000, v58
    s_waitcnt lgkmcnt(6)
    v_mfma_f32_32x32x16_bf16 v[112:127], v[24:27], v[16:19], v[112:127]
    ds_read_b128 v[72:75], v59 offset:0
    ds_read_b64_tr_b16 v[80:81], v60 offset:43008
    v_mfma_f32_32x32x16_bf16 v[176:191], v[24:27], v[20:23], v[176:191]
    ds_read_b64_tr_b16 v[82:83], v60 offset:43520
    ds_read_b128 v[76:79], v59 offset:4096
    v_mfma_f32_32x32x16_bf16 v[144:159], v[28:31], v[16:19], v[144:159]
    ds_read_b64_tr_b16 v[84:85], v60 offset:47104
    ds_read_b64_tr_b16 v[86:87], v60 offset:47616
    v_mfma_f32_32x32x16_bf16 v[208:223], v[28:31], v[20:23], v[208:223]
    v_add_u32 v59, 0x4000, v59
    s_waitcnt lgkmcnt(6)
    v_mfma_f32_32x32x16_bf16 v[112:127], v[44:47], v[36:39], v[112:127]
    s_barrier
    ds_read_b128 v[16:19], v56 offset:0
    ds_read_b64_tr_b16 v[24:25], v60 offset:0
    v_mfma_f32_32x32x16_bf16 v[176:191], v[44:47], v[40:43], v[176:191]
    ds_read_b64_tr_b16 v[26:27], v60 offset:512
    ds_read_b128 v[20:23], v56 offset:4096
    v_mfma_f32_32x32x16_bf16 v[144:159], v[48:51], v[36:39], v[144:159]
    ds_read_b64_tr_b16 v[28:29], v60 offset:4096
    ds_read_b64_tr_b16 v[30:31], v60 offset:4608
    v_mfma_f32_32x32x16_bf16 v[208:223], v[48:51], v[40:43], v[208:223]
    v_add_u32 v56, 0x4000, v56
    s_waitcnt lgkmcnt(6)
    v_mfma_f32_32x32x16_bf16 v[112:127], v[80:83], v[72:75], v[112:127]
    ds_read_b128 v[36:39], v57 offset:0
    ds_read_b64_tr_b16 v[44:45], v60 offset:2048
    v_mfma_f32_32x32x16_bf16 v[176:191], v[80:83], v[76:79], v[176:191]
    ds_read_b64_tr_b16 v[46:47], v60 offset:2560
    ds_read_b128 v[40:43], v57 offset:4096
    v_mfma_f32_32x32x16_bf16 v[144:159], v[84:87], v[72:75], v[144:159]
    ds_read_b64_tr_b16 v[48:49], v60 offset:6144
    ds_read_b64_tr_b16 v[50:51], v60 offset:6656
    v_mfma_f32_32x32x16_bf16 v[208:223], v[84:87], v[76:79], v[208:223]
    v_add_u32 v57, 0x4000, v57
    s_waitcnt lgkmcnt(6)
    v_mfma_f32_32x32x16_bf16 v[112:127], v[24:27], v[16:19], v[112:127]
    s_barrier
    ds_read_b128 v[72:75], v58 offset:0
    ds_read_b64_tr_b16 v[80:81], v60 offset:8192
    v_mfma_f32_32x32x16_bf16 v[176:191], v[24:27], v[20:23], v[176:191]
    ds_read_b64_tr_b16 v[82:83], v60 offset:8704
    ds_read_b128 v[76:79], v58 offset:4096
    v_mfma_f32_32x32x16_bf16 v[144:159], v[28:31], v[16:19], v[144:159]
    ds_read_b64_tr_b16 v[84:85], v60 offset:12288
    ds_read_b64_tr_b16 v[86:87], v60 offset:12800
    v_mfma_f32_32x32x16_bf16 v[208:223], v[28:31], v[20:23], v[208:223]
    v_add_u32 v58, 0x4000, v58
    s_waitcnt lgkmcnt(6)
    v_mfma_f32_32x32x16_bf16 v[112:127], v[44:47], v[36:39], v[112:127]
    ds_read_b128 v[16:19], v59 offset:0
    ds_read_b64_tr_b16 v[24:25], v60 offset:10240
    v_mfma_f32_32x32x16_bf16 v[176:191], v[44:47], v[40:43], v[176:191]
    ds_read_b64_tr_b16 v[26:27], v60 offset:10752
    ds_read_b128 v[20:23], v59 offset:4096
    v_mfma_f32_32x32x16_bf16 v[144:159], v[48:51], v[36:39], v[144:159]
    ds_read_b64_tr_b16 v[28:29], v60 offset:14336
    ds_read_b64_tr_b16 v[30:31], v60 offset:14848
    v_mfma_f32_32x32x16_bf16 v[208:223], v[48:51], v[40:43], v[208:223]
    v_add_u32 v59, 0x4000, v59
    s_waitcnt lgkmcnt(6)
    v_mfma_f32_32x32x16_bf16 v[112:127], v[80:83], v[72:75], v[112:127]
    ds_read_b128 v[36:39], v56 offset:0
    ds_read_b64_tr_b16 v[44:45], v60 offset:16384
    v_mfma_f32_32x32x16_bf16 v[176:191], v[80:83], v[76:79], v[176:191]
    ds_read_b64_tr_b16 v[46:47], v60 offset:16896
    ds_read_b128 v[40:43], v56 offset:4096
    v_mfma_f32_32x32x16_bf16 v[144:159], v[84:87], v[72:75], v[144:159]
    ds_read_b64_tr_b16 v[48:49], v60 offset:20480
    ds_read_b64_tr_b16 v[50:51], v60 offset:20992
    v_mfma_f32_32x32x16_bf16 v[208:223], v[84:87], v[76:79], v[208:223]
    s_waitcnt lgkmcnt(6)
    v_mfma_f32_32x32x16_bf16 v[112:127], v[24:27], v[16:19], v[112:127]
    ds_read_b128 v[72:75], v57 offset:0
    ds_read_b64_tr_b16 v[80:81], v60 offset:18432
    v_mfma_f32_32x32x16_bf16 v[176:191], v[24:27], v[20:23], v[176:191]
    ds_read_b64_tr_b16 v[82:83], v60 offset:18944
    ds_read_b128 v[76:79], v57 offset:4096
    v_mfma_f32_32x32x16_bf16 v[144:159], v[28:31], v[16:19], v[144:159]
    ds_read_b64_tr_b16 v[84:85], v60 offset:22528
    ds_read_b64_tr_b16 v[86:87], v60 offset:23040
    v_mfma_f32_32x32x16_bf16 v[208:223], v[28:31], v[20:23], v[208:223]
    s_waitcnt lgkmcnt(6)
    v_mfma_f32_32x32x16_bf16 v[112:127], v[44:47], v[36:39], v[112:127]
    ds_read_b128 v[16:19], v58 offset:0
    ds_read_b64_tr_b16 v[24:25], v60 offset:24576
    v_mfma_f32_32x32x16_bf16 v[176:191], v[44:47], v[40:43], v[176:191]
    ds_read_b64_tr_b16 v[26:27], v60 offset:25088
    ds_read_b128 v[20:23], v58 offset:4096
    v_mfma_f32_32x32x16_bf16 v[144:159], v[48:51], v[36:39], v[144:159]
    ds_read_b64_tr_b16 v[28:29], v60 offset:28672
    ds_read_b64_tr_b16 v[30:31], v60 offset:29184
    v_mfma_f32_32x32x16_bf16 v[208:223], v[48:51], v[40:43], v[208:223]
    s_waitcnt lgkmcnt(6)
    v_mfma_f32_32x32x16_bf16 v[112:127], v[80:83], v[72:75], v[112:127]
    ds_read_b128 v[36:39], v59 offset:0
    ds_read_b64_tr_b16 v[44:45], v60 offset:26624
    v_mfma_f32_32x32x16_bf16 v[176:191], v[80:83], v[76:79], v[176:191]
    ds_read_b64_tr_b16 v[46:47], v60 offset:27136
    ds_read_b128 v[40:43], v59 offset:4096
    v_mfma_f32_32x32x16_bf16 v[144:159], v[84:87], v[72:75], v[144:159]
    ds_read_b64_tr_b16 v[48:49], v60 offset:30720
    ds_read_b64_tr_b16 v[50:51], v60 offset:31232
    v_mfma_f32_32x32x16_bf16 v[208:223], v[84:87], v[76:79], v[208:223]
    s_waitcnt lgkmcnt(6)
    v_mfma_f32_32x32x16_bf16 v[112:127], v[24:27], v[16:19], v[112:127]
    v_mfma_f32_32x32x16_bf16 v[176:191], v[24:27], v[20:23], v[176:191]
    v_mfma_f32_32x32x16_bf16 v[144:159], v[28:31], v[16:19], v[144:159]
    v_mfma_f32_32x32x16_bf16 v[208:223], v[28:31], v[20:23], v[208:223]
    s_waitcnt lgkmcnt(0)
    v_mfma_f32_32x32x16_bf16 v[112:127], v[44:47], v[36:39], v[112:127]
    v_mfma_f32_32x32x16_bf16 v[176:191], v[44:47], v[40:43], v[176:191]
    v_mfma_f32_32x32x16_bf16 v[144:159], v[48:51], v[36:39], v[144:159]
    v_mfma_f32_32x32x16_bf16 v[208:223], v[48:51], v[40:43], v[208:223]
L_p2done:
    s_nop 8
    v_pk_mul_f32 v[16:17], v[112:113], v[112:113]
    v_pk_mul_f32 v[18:19], v[114:115], v[114:115]
    v_pk_mul_f32 v[20:21], v[116:117], v[116:117]
    v_pk_mul_f32 v[22:23], v[118:119], v[118:119]
    v_pk_fma_f32 v[16:17], v[16:17], v[10:11], v[12:13]
    v_pk_fma_f32 v[18:19], v[18:19], v[10:11], v[12:13]
    v_pk_fma_f32 v[20:21], v[20:21], v[10:11], v[12:13]
    v_pk_fma_f32 v[22:23], v[22:23], v[10:11], v[12:13]
    v_pk_mul_f32 v[16:17], v[16:17], v[112:113]
    v_pk_mul_f32 v[18:19], v[18:19], v[114:115]
    v_pk_mul_f32 v[20:21], v[20:21], v[116:117]
    v_pk_mul_f32 v[22:23], v[22:23], v[118:119]
    s_mov_b64 exec, 1
    ds_add_u32 v14, v15
    s_mov_b64 exec, -1
    v_exp_f32 v16, v16
    v_exp_f32 v17, v17
    v_exp_f32 v18, v18
    v_exp_f32 v19, v19
    v_exp_f32 v20, v20
    v_exp_f32 v21, v21
    v_exp_f32 v22, v22
    v_exp_f32 v23, v23
    v_pk_mul_f32 v[144:145], v[144:145], v[112:113]
    v_pk_mul_f32 v[146:147], v[146:147], v[114:115]
    v_pk_mul_f32 v[148:149], v[148:149], v[116:117]
    v_pk_mul_f32 v[150:151], v[150:151], v[118:119]
    v_pk_add_f32 v[16:17], v[16:17], 1.0 op_sel_hi:[1,0]
    v_pk_add_f32 v[18:19], v[18:19], 1.0 op_sel_hi:[1,0]
    v_pk_add_f32 v[20:21], v[20:21], 1.0 op_sel_hi:[1,0]
    v_pk_add_f32 v[22:23], v[22:23], 1.0 op_sel_hi:[1,0]
    v_rcp_f32 v16, v16
    v_rcp_f32 v17, v17
    v_rcp_f32 v18, v18
    v_rcp_f32 v19, v19
    v_rcp_f32 v20, v20
    v_rcp_f32 v21, v21
    v_rcp_f32 v22, v22
    v_rcp_f32 v23, v23
    v_pk_mul_f32 v[144:145], v[144:145], v[16:17]
    v_pk_mul_f32 v[146:147], v[146:147], v[18:19]
    v_pk_mul_f32 v[148:149], v[148:149], v[20:21]
    v_pk_mul_f32 v[150:151], v[150:151], v[22:23]
    v_cvt_pk_bf16_f32 v224, v144, v145
    v_cvt_pk_bf16_f32 v225, v146, v147
    v_cvt_pk_bf16_f32 v226, v148, v149
    v_cvt_pk_bf16_f32 v227, v150, v151
    v_pk_mul_f32 v[24:25], v[120:121], v[120:121]
    v_pk_mul_f32 v[26:27], v[122:123], v[122:123]
    v_pk_mul_f32 v[28:29], v[124:125], v[124:125]
    v_pk_mul_f32 v[30:31], v[126:127], v[126:127]
    v_pk_fma_f32 v[24:25], v[24:25], v[10:11], v[12:13]
    v_pk_fma_f32 v[26:27], v[26:27], v[10:11], v[12:13]
    v_pk_fma_f32 v[28:29], v[28:29], v[10:11], v[12:13]
    v_pk_fma_f32 v[30:31], v[30:31], v[10:11], v[12:13]
    v_pk_mul_f32 v[24:25], v[24:25], v[120:121]
    v_pk_mul_f32 v[26:27], v[26:27], v[122:123]
    v_pk_mul_f32 v[28:29], v[28:29], v[124:125]
    v_pk_mul_f32 v[30:31], v[30:31], v[126:127]
    v_exp_f32 v24, v24
    v_exp_f32 v25, v25
    v_exp_f32 v26, v26
    v_exp_f32 v27, v27
    v_exp_f32 v28, v28
    v_exp_f32 v29, v29
    v_exp_f32 v30, v30
    v_exp_f32 v31, v31
    v_pk_mul_f32 v[152:153], v[152:153], v[120:121]
    v_pk_mul_f32 v[154:155], v[154:155], v[122:123]
    v_pk_mul_f32 v[156:157], v[156:157], v[124:125]
    v_pk_mul_f32 v[158:159], v[158:159], v[126:127]
    v_pk_add_f32 v[24:25], v[24:25], 1.0 op_sel_hi:[1,0]
    v_pk_add_f32 v[26:27], v[26:27], 1.0 op_sel_hi:[1,0]
    v_pk_add_f32 v[28:29], v[28:29], 1.0 op_sel_hi:[1,0]
    v_pk_add_f32 v[30:31], v[30:31], 1.0 op_sel_hi:[1,0]
    v_rcp_f32 v24, v24
    v_rcp_f32 v25, v25
    v_rcp_f32 v26, v26
    v_rcp_f32 v27, v27
    v_rcp_f32 v28, v28
    v_rcp_f32 v29, v29
    v_rcp_f32 v30, v30
    v_rcp_f32 v31, v31
    v_pk_mul_f32 v[152:153], v[152:153], v[24:25]
    v_pk_mul_f32 v[154:155], v[154:155], v[26:27]
    v_pk_mul_f32 v[156:157], v[156:157], v[28:29]
    v_pk_mul_f32 v[158:159], v[158:159], v[30:31]
    v_cvt_pk_bf16_f32 v228, v152, v153
    v_cvt_pk_bf16_f32 v229, v154, v155
    v_cvt_pk_bf16_f32 v230, v156, v157
    v_cvt_pk_bf16_f32 v231, v158, v159
    v_pk_mul_f32 v[16:17], v[176:177], v[176:177]
    v_pk_mul_f32 v[18:19], v[178:179], v[178:179]
    v_pk_mul_f32 v[20:21], v[180:181], v[180:181]
    v_pk_mul_f32 v[22:23], v[182:183], v[182:183]
    v_pk_fma_f32 v[16:17], v[16:17], v[10:11], v[12:13]
    v_pk_fma_f32 v[18:19], v[18:19], v[10:11], v[12:13]
    v_pk_fma_f32 v[20:21], v[20:21], v[10:11], v[12:13]
    v_pk_fma_f32 v[22:23], v[22:23], v[10:11], v[12:13]
    v_pk_mul_f32 v[16:17], v[16:17], v[176:177]
    v_pk_mul_f32 v[18:19], v[18:19], v[178:179]
    v_pk_mul_f32 v[20:21], v[20:21], v[180:181]
    v_pk_mul_f32 v[22:23], v[22:23], v[182:183]
    v_exp_f32 v16, v16
    v_exp_f32 v17, v17
    v_exp_f32 v18, v18
    v_exp_f32 v19, v19
    v_exp_f32 v20, v20
    v_exp_f32 v21, v21
    v_exp_f32 v22, v22
    v_exp_f32 v23, v23
    v_pk_mul_f32 v[208:209], v[208:209], v[176:177]
    v_pk_mul_f32 v[210:211], v[210:211], v[178:179]
    v_pk_mul_f32 v[212:213], v[212:213], v[180:181]
    v_pk_mul_f32 v[214:215], v[214:215], v[182:183]
    v_pk_add_f32 v[16:17], v[16:17], 1.0 op_sel_hi:[1,0]
    v_pk_add_f32 v[18:19], v[18:19], 1.0 op_sel_hi:[1,0]
    v_pk_add_f32 v[20:21], v[20:21], 1.0 op_sel_hi:[1,0]
    v_pk_add_f32 v[22:23], v[22:23], 1.0 op_sel_hi:[1,0]
    v_rcp_f32 v16, v16
    v_rcp_f32 v17, v17
    v_rcp_f32 v18, v18
    v_rcp_f32 v19, v19
    v_rcp_f32 v20, v20
    v_rcp_f32 v21, v21
    v_rcp_f32 v22, v22
    v_rcp_f32 v23, v23
    v_pk_mul_f32 v[208:209], v[208:209], v[16:17]
    v_pk_mul_f32 v[210:211], v[210:211], v[18:19]
    v_pk_mul_f32 v[212:213], v[212:213], v[20:21]
    v_pk_mul_f32 v[214:215], v[214:215], v[22:23]
    v_cvt_pk_bf16_f32 v232, v208, v209
    v_cvt_pk_bf16_f32 v233, v210, v211
    v_cvt_pk_bf16_f32 v234, v212, v213
    v_cvt_pk_bf16_f32 v235, v214, v215
    v_pk_mul_f32 v[24:25], v[184:185], v[184:185]
    v_pk_mul_f32 v[26:27], v[186:187], v[186:187]
    v_pk_mul_f32 v[28:29], v[188:189], v[188:189]
    v_pk_mul_f32 v[30:31], v[190:191], v[190:191]
    v_pk_fma_f32 v[24:25], v[24:25], v[10:11], v[12:13]
    v_pk_fma_f32 v[26:27], v[26:27], v[10:11], v[12:13]
    v_pk_fma_f32 v[28:29], v[28:29], v[10:11], v[12:13]
    v_pk_fma_f32 v[30:31], v[30:31], v[10:11], v[12:13]
    v_pk_mul_f32 v[24:25], v[24:25], v[184:185]
    v_pk_mul_f32 v[26:27], v[26:27], v[186:187]
    v_pk_mul_f32 v[28:29], v[28:29], v[188:189]
    v_pk_mul_f32 v[30:31], v[30:31], v[190:191]
    v_exp_f32 v24, v24
    v_exp_f32 v25, v25
    v_exp_f32 v26, v26
    v_exp_f32 v27, v27
    v_exp_f32 v28, v28
    v_exp_f32 v29, v29
    v_exp_f32 v30, v30
    v_exp_f32 v31, v31
    v_pk_mul_f32 v[216:217], v[216:217], v[184:185]
    v_pk_mul_f32 v[218:219], v[218:219], v[186:187]
    v_pk_mul_f32 v[220:221], v[220:221], v[188:189]
    v_pk_mul_f32 v[222:223], v[222:223], v[190:191]
    v_pk_add_f32 v[24:25], v[24:25], 1.0 op_sel_hi:[1,0]
    v_pk_add_f32 v[26:27], v[26:27], 1.0 op_sel_hi:[1,0]
    v_pk_add_f32 v[28:29], v[28:29], 1.0 op_sel_hi:[1,0]
    v_pk_add_f32 v[30:31], v[30:31], 1.0 op_sel_hi:[1,0]
    v_rcp_f32 v24, v24
    v_rcp_f32 v25, v25
    v_rcp_f32 v26, v26
    v_rcp_f32 v27, v27
    v_rcp_f32 v28, v28
    v_rcp_f32 v29, v29
    v_rcp_f32 v30, v30
    v_rcp_f32 v31, v31
    v_pk_mul_f32 v[216:217], v[216:217], v[24:25]
    v_pk_mul_f32 v[218:219], v[218:219], v[26:27]
    v_pk_mul_f32 v[220:221], v[220:221], v[28:29]
    v_pk_mul_f32 v[222:223], v[222:223], v[30:31]
    v_cvt_pk_bf16_f32 v236, v216, v217
    v_cvt_pk_bf16_f32 v237, v218, v219
    v_cvt_pk_bf16_f32 v238, v220, v221
    v_cvt_pk_bf16_f32 v239, v222, v223
L_attn:
    v_mov_b32 v182, s73
    v_writelane_b32 v182, s72, 1
    v_mov_b32 v183, 1
    v_mov_b32 v184, 163828
    v_and_b32 v187, 15, v2
    v_lshlrev_b32 v187, 7, v187
    v_mov_b32 v185, s95
    v_mov_b32 v186, s89
    v_cmp_gt_u32 vcc, 32, v2
    s_nop 1
    v_cndmask_b32 v185, v186, v185, vcc
    v_lshl_add_u32 v188, v2, 7, v185
    v_lshlrev_b32 v194, 7, v2
    v_mov_b32 v181, 163824
    s_cmp_lt_u32 s3, 4
    s_cbranch_scc1 L_x1
    s_add_u32 s94, s59, 16384
    s_and_b32 s94, s94, 0xffff
    s_add_u32 s94, s94, s56
    s_add_u32 m0, s57, 16384
    s_add_u32 s67, s94, 2097152
    buffer_load_dwordx4 v3, s[28:31], s67 offen offset:0 sc1 lds
    buffer_load_dwordx4 v3, s[28:31], s67 offen offset:1024 sc1 lds
    s_add_u32 s67, s94, 4194304
    s_add_u32 m0, s58, 83200
    s_nop 0
    buffer_load_dwordx4 v3, s[28:31], s67 offen offset:0 sc1 lds
    s_add_u32 m0, s58, 83280
    s_nop 0
    buffer_load_dwordx4 v3, s[28:31], s67 offen offset:1024 sc1 lds
    s_add_u32 s94, s59, 24576
    s_and_b32 s94, s94, 0xffff
    s_add_u32 s94, s94, s56
    s_add_u32 m0, s57, 24576
    s_add_u32 s67, s94, 2097152
    buffer_load_dwordx4 v3, s[28:31], s67 offen offset:0 sc1 lds
    buffer_load_dwordx4 v3, s[28:31], s67 offen offset:1024 sc1 lds
    s_add_u32 s67, s94, 4194304
    s_add_u32 m0, s58, 92032
    s_nop 0
    buffer_load_dwordx4 v3, s[28:31], s67 offen offset:0 sc1 lds
    s_add_u32 m0, s58, 92112
    s_nop 0
    buffer_load_dwordx4 v3, s[28:31], s67 offen offset:1024 sc1 lds
    s_waitcnt vmcnt(9) lgkmcnt(0)
    s_mov_b64 exec, 1
    ds_add_u32 v181, v183 offset:8
    s_mov_b64 exec, -1
L_x1:
    s_setprio 3
    s_mov_b32 s98, 8388608
L_x1w:
    ds_read_b32 v180, v181 offset:8
    s_waitcnt lgkmcnt(0)
    v_cmp_ne_u32 vcc, 4, v180
    s_nop 0
    s_cbranch_vccz L_x1w_ok
    s_sleep 1
    s_sub_u32 s98, s98, 1
    s_cmp_lg_u32 s98, 0
    s_cbranch_scc1 L_x1w
L_x1w_ok:
    ds_read_b128 v[12:15], v8 offset:1024
    ds_read_b128 v[8:11], v8
    ds_read_b128 v[104:107], v3
    ds_read_b128 v[96:99], v4
    ds_read_b128 v[100:103], v5
    s_cmp_ge_u32 s3, 4
    s_cbranch_scc1 L_st4o
    buffer_store_dwordx4 v[224:227], v3, s[28:31], s36 offen sc1
    buffer_store_dwordx4 v[228:231], v3, s[28:31], s37 offen sc1
    buffer_store_dwordx4 v[232:235], v3, s[28:31], s38 offen sc1
    buffer_store_dwordx4 v[236:239], v3, s[28:31], s39 offen sc1
    s_cmp_lg_u32 s62, 0
    s_cbranch_scc1 L_st4o
    buffer_store_dwordx4 v[240:243], v3, s[28:31], s40 offen sc1
    buffer_store_dwordx4 v[244:247], v3, s[28:31], s41 offen sc1
    buffer_store_dwordx4 v[248:251], v3, s[28:31], s42 offen sc1
    buffer_store_dwordx4 v[252:255], v3, s[28:31], s43 offen sc1
L_st4o:
    s_waitcnt lgkmcnt(0)
    v_mfma_f32_32x32x16_bf16 v[64:79], v[104:107], v[8:11], 0
    v_mfma_f32_32x32x16_bf16 v[80:95], v[104:107], v[12:15], 0
    s_nop 10
    v_max3_f32 v108, v64, v65, v66
    v_max3_f32 v109, v72, v73, v74
    v_max3_f32 v110, v80, v81, v82
    v_max3_f32 v111, v88, v89, v90
    v_max3_f32 v108, v67, v68, v108
    v_max3_f32 v109, v75, v76, v109
    v_max3_f32 v110, v83, v84, v110
    v_max3_f32 v111, v91, v92, v111
    v_max3_f32 v108, v69, v70, v108
    v_max3_f32 v109, v77, v78, v109
    v_max3_f32 v110, v85, v86, v110
    v_max3_f32 v111, v93, v94, v111
    v_max3_f32 v108, v71, v79, v108
    v_max3_f32 v110, v87, v95, v110
    v_max3_f32 v108, v108, v109, v111
    v_max_f32 v108, v108, v110
    v_mov_b32 v109, v108
    s_nop 1
    v_permlane32_swap_b32 v109, v108
    v_max_f32 v108, v109, v108
    v_sub_f32 v16, 0, v108
    v_sub_f32 v17, 0, v108
    v_sub_f32 v18, 0, v108
    v_sub_f32 v19, 0, v108
    v_sub_f32 v20, 0, v108
    v_sub_f32 v21, 0, v108
    v_sub_f32 v22, 0, v108
    v_sub_f32 v23, 0, v108
    v_sub_f32 v24, 0, v108
    v_sub_f32 v25, 0, v108
    v_sub_f32 v26, 0, v108
    v_sub_f32 v27, 0, v108
    v_sub_f32 v28, 0, v108
    v_sub_f32 v29, 0, v108
    v_sub_f32 v30, 0, v108
    v_sub_f32 v31, 0, v108
    s_waitcnt lgkmcnt(0)
    s_nop 0
    v_mfma_f32_32x32x16_bf16 v[64:79], v[96:99], v[8:11], v[16:31]
    s_nop 11
    v_exp_f32 v64, v64
    v_exp_f32 v65, v65
    ds_read_b128 v[108:111], v6 offset:0
    ds_read_b128 v[104:107], v5 offset:2208
    v_exp_f32 v66, v66
    v_exp_f32 v67, v67
    v_exp_f32 v68, v68
    v_exp_f32 v69, v69
    v_mfma_f32_32x32x16_bf16 v[80:95], v[96:99], v[12:15], v[16:31]
    ds_read_b128 v[96:99], v4 offset:2048
    v_exp_f32 v70, v70
    v_exp_f32 v71, v71
    v_exp_f32 v72, v72
    v_cvt_pk_bf16_f32 v64, v64, v65
    v_cvt_pk_bf16_f32 v65, v66, v67
    v_cvt_pk_bf16_f32 v66, v68, v69
    v_cvt_pk_bf16_f32 v67, v70, v71
    v_exp_f32 v73, v73
    v_exp_f32 v74, v74
    v_mfma_f32_32x32x16_bf16 v[32:47], v[100:103], v[64:67], 0
    v_exp_f32 v75, v75
    v_exp_f32 v76, v76
    v_exp_f32 v77, v77
    v_exp_f32 v78, v78
    v_exp_f32 v79, v79
    v_cvt_pk_bf16_f32 v72, v72, v73
    v_cvt_pk_bf16_f32 v73, v74, v75
    v_cvt_pk_bf16_f32 v74, v76, v77
    v_cvt_pk_bf16_f32 v75, v78, v79
    v_exp_f32 v80, v80
    v_exp_f32 v81, v81
    s_waitcnt lgkmcnt(0)
    v_mfma_f32_32x32x16_bf16 v[32:47], v[108:111], v[72:75], v[32:47]
    v_exp_f32 v82, v82
    v_exp_f32 v83, v83
    v_exp_f32 v84, v84
    v_exp_f32 v85, v85
    v_mfma_f32_32x32x16_bf16 v[64:79], v[96:99], v[8:11], v[16:31]
    v_exp_f32 v86, v86
    v_exp_f32 v87, v87
    v_exp_f32 v88, v88
    v_cvt_pk_bf16_f32 v80, v80, v81
    v_cvt_pk_bf16_f32 v81, v82, v83
    v_cvt_pk_bf16_f32 v82, v84, v85
    v_cvt_pk_bf16_f32 v83, v86, v87
    v_exp_f32 v89, v89
    v_exp_f32 v90, v90
    v_mfma_f32_32x32x16_bf16 v[48:63], v[100:103], v[80:83], 0
    v_exp_f32 v91, v91
    v_exp_f32 v92, v92
    v_exp_f32 v93, v93
    v_exp_f32 v94, v94
    v_exp_f32 v95, v95
    v_cvt_pk_bf16_f32 v88, v88, v89
    v_cvt_pk_bf16_f32 v89, v90, v91
    v_cvt_pk_bf16_f32 v90, v92, v93
    v_cvt_pk_bf16_f32 v91, v94, v95
    v_exp_f32 v64, v64
    v_exp_f32 v65, v65
    v_mfma_f32_32x32x16_bf16 v[48:63], v[108:111], v[88:91], v[48:63]
    ds_read_b128 v[108:111], v6 offset:2208
    ds_read_b128 v[100:103], v5 offset:4416
    v_exp_f32 v66, v66
    v_exp_f32 v67, v67
    v_exp_f32 v68, v68
    v_exp_f32 v69, v69
    v_mfma_f32_32x32x16_bf16 v[80:95], v[96:99], v[12:15], v[16:31]
    ds_read_b128 v[96:99], v4 offset:4096
    v_exp_f32 v70, v70
    v_exp_f32 v71, v71
    v_exp_f32 v72, v72
    v_cvt_pk_bf16_f32 v64, v64, v65
    v_cvt_pk_bf16_f32 v65, v66, v67
    v_cvt_pk_bf16_f32 v66, v68, v69
    v_cvt_pk_bf16_f32 v67, v70, v71
    v_exp_f32 v73, v73
    v_exp_f32 v74, v74
    v_mfma_f32_32x32x16_bf16 v[32:47], v[104:107], v[64:67], v[32:47]
    v_exp_f32 v75, v75
    v_exp_f32 v76, v76
    v_exp_f32 v77, v77
    v_exp_f32 v78, v78
    s_cmp_lt_u32 s3, 4
    s_cbranch_scc1 L_st4y
    buffer_store_dwordx4 v[224:227], v3, s[28:31], s36 offen sc1
    buffer_store_dwordx4 v[228:231], v3, s[28:31], s37 offen sc1
    buffer_store_dwordx4 v[232:235], v3, s[28:31], s38 offen sc1
    buffer_store_dwordx4 v[236:239], v3, s[28:31], s39 offen sc1
L_st4y:
    v_exp_f32 v79, v79
    v_cvt_pk_bf16_f32 v72, v72, v73
    v_cvt_pk_bf16_f32 v73, v74, v75
    v_cvt_pk_bf16_f32 v74, v76, v77
    v_cvt_pk_bf16_f32 v75, v78, v79
    v_exp_f32 v80, v80
    v_exp_f32 v81, v81
    s_waitcnt lgkmcnt(0)
    v_mfma_f32_32x32x16_bf16 v[32:47], v[108:111], v[72:75], v[32:47]
    v_exp_f32 v82, v82
    v_exp_f32 v83, v83
    v_exp_f32 v84, v84
    v_exp_f32 v85, v85
    v_mfma_f32_32x32x16_bf16 v[64:79], v[96:99], v[8:11], v[16:31]
    v_exp_f32 v86, v86
    v_exp_f32 v87, v87
    v_exp_f32 v88, v88
    v_cvt_pk_bf16_f32 v80, v80, v81
    v_cvt_pk_bf16_f32 v81, v82, v83
    v_cvt_pk_bf16_f32 v82, v84, v85
    v_cvt_pk_bf16_f32 v83, v86, v87
    v_exp_f32 v89, v89
    v_exp_f32 v90, v90
    v_mfma_f32_32x32x16_bf16 v[48:63], v[104:107], v[80:83], v[48:63]
    v_exp_f32 v91, v91
    v_exp_f32 v92, v92
    v_exp_f32 v93, v93
    v_exp_f32 v94, v94
    s_cmp_lg_u32 s3, 4
    s_cbranch_scc1 L_s1b0
    s_mov_b32 s70, 21495808
    buffer_load_dwordx2 v[196:197], v194, s[28:31], s70 offen sc1
    s_mov_b32 s70, 21504000
    buffer_load_dwordx2 v[198:199], v194, s[28:31], s70 offen sc1
    s_mov_b32 s70, 21512192
    buffer_load_dwordx2 v[200:201], v194, s[28:31], s70 offen sc1
    s_mov_b32 s70, 21520384
    buffer_load_dwordx2 v[202:203], v194, s[28:31], s70 offen sc1
L_s1b0:
    v_exp_f32 v95, v95
    v_cvt_pk_bf16_f32 v88, v88, v89
    v_cvt_pk_bf16_f32 v89, v90, v91
    v_cvt_pk_bf16_f32 v90, v92, v93
    v_cvt_pk_bf16_f32 v91, v94, v95
    s_setprio 2
    v_exp_f32 v64, v64
    v_exp_f32 v65, v65
    v_mfma_f32_32x32x16_bf16 v[48:63], v[108:111], v[88:91], v[48:63]
    ds_read_b128 v[108:111], v6 offset:4416
    ds_read_b128 v[104:107], v5 offset:6624
    v_exp_f32 v66, v66
    v_exp_f32 v67, v67
    v_exp_f32 v68, v68
    v_exp_f32 v69, v69
    v_mfma_f32_32x32x16_bf16 v[80:95], v[96:99], v[12:15], v[16:31]
    ds_read_b128 v[96:99], v4 offset:6144
    v_exp_f32 v70, v70
    v_exp_f32 v71, v71
    v_exp_f32 v72, v72
    v_cvt_pk_bf16_f32 v64, v64, v65
    v_cvt_pk_bf16_f32 v65, v66, v67
    v_cvt_pk_bf16_f32 v66, v68, v69
    v_cvt_pk_bf16_f32 v67, v70, v71
    v_exp_f32 v73, v73
    v_exp_f32 v74, v74
    v_mfma_f32_32x32x16_bf16 v[32:47], v[100:103], v[64:67], v[32:47]
    v_exp_f32 v75, v75
    v_exp_f32 v76, v76
    v_exp_f32 v77, v77
    v_exp_f32 v78, v78
    v_exp_f32 v79, v79
    v_cvt_pk_bf16_f32 v72, v72, v73
    v_cvt_pk_bf16_f32 v73, v74, v75
    v_cvt_pk_bf16_f32 v74, v76, v77
    v_cvt_pk_bf16_f32 v75, v78, v79
    v_exp_f32 v80, v80
    v_exp_f32 v81, v81
    s_waitcnt lgkmcnt(0)
    v_mfma_f32_32x32x16_bf16 v[32:47], v[108:111], v[72:75], v[32:47]
    v_exp_f32 v82, v82
    v_exp_f32 v83, v83
    v_exp_f32 v84, v84
    v_exp_f32 v85, v85
    v_mfma_f32_32x32x16_bf16 v[64:79], v[96:99], v[8:11], v[16:31]
    v_exp_f32 v86, v86
    v_exp_f32 v87, v87
    v_exp_f32 v88, v88
    v_cvt_pk_bf16_f32 v80, v80, v81
    v_cvt_pk_bf16_f32 v81, v82, v83
    v_cvt_pk_bf16_f32 v82, v84, v85
    v_cvt_pk_bf16_f32 v83, v86, v87
    v_exp_f32 v89, v89
    v_exp_f32 v90, v90
    v_mfma_f32_32x32x16_bf16 v[48:63], v[100:103], v[80:83], v[48:63]
    v_exp_f32 v91, v91
    v_exp_f32 v92, v92
    v_exp_f32 v93, v93
    v_exp_f32 v94, v94
    s_waitcnt vmcnt(0)
    s_cmp_lg_u32 s3, 4
    s_cbranch_scc1 L_ps1b_ok
    v_xor_b32 v196, v196, v192
    v_xor_b32 v197, v197, v193
    v_xor_b32 v198, v198, v192
    v_xor_b32 v199, v199, v193
    v_xor_b32 v200, v200, v192
    v_xor_b32 v201, v201, v193
    v_xor_b32 v202, v202, v192
    v_xor_b32 v203, v203, v193
    v_or3_b32 v196, v196, v197, v198
    v_or3_b32 v199, v199, v200, v201
    v_or3_b32 v196, v196, v202, v203
    v_or_b32 v196, v196, v199
    v_cmp_ne_u32 vcc, 0, v196
    s_nop 0
    s_cbranch_vccz L_ps1b_ok
    s_mov_b32 s98, 1048576
L_ps1b:
    s_mov_b32 s70, 21495808
    buffer_load_dwordx2 v[196:197], v194, s[28:31], s70 offen sc1
    s_mov_b32 s70, 21504000
    buffer_load_dwordx2 v[198:199], v194, s[28:31], s70 offen sc1
    s_mov_b32 s70, 21512192
    buffer_load_dwordx2 v[200:201], v194, s[28:31], s70 offen sc1
    s_mov_b32 s70, 21520384
    buffer_load_dwordx2 v[202:203], v194, s[28:31], s70 offen sc1
    s_waitcnt vmcnt(0)
    v_xor_b32 v196, v196, v192
    v_xor_b32 v197, v197, v193
    v_xor_b32 v198, v198, v192
    v_xor_b32 v199, v199, v193
    v_xor_b32 v200, v200, v192
    v_xor_b32 v201, v201, v193
    v_xor_b32 v202, v202, v192
    v_xor_b32 v203, v203, v193
    v_or3_b32 v196, v196, v197, v198
    v_or3_b32 v199, v199, v200, v201
    v_or3_b32 v196, v196, v202, v203
    v_or_b32 v196, v196, v199
    v_cmp_ne_u32 vcc, 0, v196
    s_nop 0
    s_cbranch_vccz L_ps1b_ok
    s_sleep 4
    s_sub_u32 s98, s98, 1
    s_cmp_lg_u32 s98, 0
    s_cbranch_scc1 L_ps1b
L_ps1b_ok:
    s_mov_b64 exec, 1
    ds_add_rtn_u32 v184, v184, v183
    s_mov_b64 exec, -1
    v_exp_f32 v95, v95
    v_cvt_pk_bf16_f32 v88, v88, v89
    v_cvt_pk_bf16_f32 v89, v90, v91
    v_cvt_pk_bf16_f32 v90, v92, v93
    v_cvt_pk_bf16_f32 v91, v94, v95
    v_mov_b32 v181, 163808
    s_mov_b32 s98, 8388608
L_free:
    ds_read_b32 v180, v181 offset:0
    s_waitcnt lgkmcnt(0)
    v_cmp_ne_u32 vcc, 4, v180
    s_nop 0
    s_cbranch_vccz L_free_ok
    s_sleep 1
    s_sub_u32 s98, s98, 1
    s_cmp_lg_u32 s98, 0
    s_cbranch_scc1 L_free
L_free_ok:
    v_mov_b32 v181, 163824
    s_cmp_lt_u32 s3, 6
    s_cbranch_scc1 L_nocs2
    ds_write_b64 v189, v[190:191]
    ds_write_b64 v189, v[190:191] offset:8
L_nocs2:
    v_exp_f32 v64, v64
    v_exp_f32 v65, v65
    v_mfma_f32_32x32x16_bf16 v[48:63], v[108:111], v[88:91], v[48:63]
    ds_read_b128 v[108:111], v6 offset:6624
    ds_read_b128 v[100:103], v5 offset:8832
    v_exp_f32 v66, v66
    v_exp_f32 v67, v67
    v_exp_f32 v68, v68
    v_exp_f32 v69, v69
    v_mfma_f32_32x32x16_bf16 v[80:95], v[96:99], v[12:15], v[16:31]
    ds_read_b128 v[96:99], v4 offset:8192
    v_exp_f32 v70, v70
    v_exp_f32 v71, v71
    v_exp_f32 v72, v72
    s_waitcnt lgkmcnt(0)
    v_readfirstlane_b32 s70, v184
    s_nop 0
    s_cmp_eq_u32 s70, 7
    s_cselect_b32 s70, 0, 0x7ff00000
    s_mov_b64 exec, 3
    s_nop 0
    buffer_store_dword v183, v182, s[28:31], s70 offen sc1
    s_mov_b64 exec, -1
    v_cvt_pk_bf16_f32 v64, v64, v65
    v_cvt_pk_bf16_f32 v65, v66, v67
    v_cvt_pk_bf16_f32 v66, v68, v69
    v_cvt_pk_bf16_f32 v67, v70, v71
    v_exp_f32 v73, v73
    v_exp_f32 v74, v74
    v_mfma_f32_32x32x16_bf16 v[32:47], v[104:107], v[64:67], v[32:47]
    v_exp_f32 v75, v75
    v_exp_f32 v76, v76
    v_exp_f32 v77, v77
    v_exp_f32 v78, v78
    s_add_u32 s94, s93, 32768
    s_and_b32 s94, s94, 0xffff
    s_add_u32 s94, s94, s90
    s_add_u32 m0, s91, 32768
    s_add_u32 s67, s94, 2097152
    buffer_load_dwordx4 v3, s[28:31], s67 offen sc1 lds
    v_exp_f32 v79, v79
    v_cvt_pk_bf16_f32 v72, v72, v73
    v_cvt_pk_bf16_f32 v73, v74, v75
    v_cvt_pk_bf16_f32 v74, v76, v77
    v_cvt_pk_bf16_f32 v75, v78, v79
    v_exp_f32 v80, v80
    v_exp_f32 v81, v81
    s_waitcnt lgkmcnt(0)
    v_mfma_f32_32x32x16_bf16 v[32:47], v[108:111], v[72:75], v[32:47]
    v_exp_f32 v82, v82
    v_exp_f32 v83, v83
    v_exp_f32 v84, v84
    v_exp_f32 v85, v85
    v_mfma_f32_32x32x16_bf16 v[64:79], v[96:99], v[8:11], v[16:31]
    v_exp_f32 v86, v86
    v_exp_f32 v87, v87
    v_exp_f32 v88, v88
    v_cvt_pk_bf16_f32 v80, v80, v81
    v_cvt_pk_bf16_f32 v81, v82, v83
    v_cvt_pk_bf16_f32 v82, v84, v85
    v_cvt_pk_bf16_f32 v83, v86, v87
    v_exp_f32 v89, v89
    v_exp_f32 v90, v90
    v_mfma_f32_32x32x16_bf16 v[48:63], v[104:107], v[80:83], v[48:63]
    v_exp_f32 v91, v91
    v_exp_f32 v92, v92
    v_exp_f32 v93, v93
    v_exp_f32 v94, v94
    s_add_u32 m0, s92, 100864
    s_add_u32 s67, s94, 4194304
    buffer_load_dwordx4 v3, s[28:31], s67 offen sc1 lds
    v_exp_f32 v95, v95
    v_cvt_pk_bf16_f32 v88, v88, v89
    v_cvt_pk_bf16_f32 v89, v90, v91
    v_cvt_pk_bf16_f32 v90, v92, v93
    v_cvt_pk_bf16_f32 v91, v94, v95
    v_exp_f32 v64, v64
    v_exp_f32 v65, v65
    v_mfma_f32_32x32x16_bf16 v[48:63], v[108:111], v[88:91], v[48:63]
    ds_read_b128 v[108:111], v6 offset:8832
    ds_read_b128 v[104:107], v5 offset:11040
    v_exp_f32 v66, v66
    v_exp_f32 v67, v67
    v_exp_f32 v68, v68
    v_exp_f32 v69, v69
    v_mfma_f32_32x32x16_bf16 v[80:95], v[96:99], v[12:15], v[16:31]
    ds_read_b128 v[96:99], v4 offset:10240
    v_exp_f32 v70, v70
    v_exp_f32 v71, v71
    v_exp_f32 v72, v72
    v_cvt_pk_bf16_f32 v64, v64, v65
    v_cvt_pk_bf16_f32 v65, v66, v67
    v_cvt_pk_bf16_f32 v66, v68, v69
    v_cvt_pk_bf16_f32 v67, v70, v71
    v_exp_f32 v73, v73
    v_exp_f32 v74, v74
    v_mfma_f32_32x32x16_bf16 v[32:47], v[100:103], v[64:67], v[32:47]
    v_exp_f32 v75, v75
    v_exp_f32 v76, v76
    v_exp_f32 v77, v77
    v_exp_f32 v78, v78
    s_add_u32 s94, s93, 40960
    s_and_b32 s94, s94, 0xffff
    s_add_u32 s94, s94, s90
    s_add_u32 m0, s91, 40960
    s_add_u32 s67, s94, 2097152
    buffer_load_dwordx4 v3, s[28:31], s67 offen sc1 lds
    v_exp_f32 v79, v79
    v_cvt_pk_bf16_f32 v72, v72, v73
    v_cvt_pk_bf16_f32 v73, v74, v75
    v_cvt_pk_bf16_f32 v74, v76, v77
    v_cvt_pk_bf16_f32 v75, v78, v79
    v_exp_f32 v80, v80
    v_exp_f32 v81, v81
    s_waitcnt lgkmcnt(0)
    v_mfma_f32_32x32x16_bf16 v[32:47], v[108:111], v[72:75], v[32:47]
    v_exp_f32 v82, v82
    v_exp_f32 v83, v83
    v_exp_f32 v84, v84
    v_exp_f32 v85, v85
    v_mfma_f32_32x32x16_bf16 v[64:79], v[96:99], v[8:11], v[16:31]
    v_exp_f32 v86, v86
    v_exp_f32 v87, v87
    v_exp_f32 v88, v88
    v_cvt_pk_bf16_f32 v80, v80, v81
    v_cvt_pk_bf16_f32 v81, v82, v83
    v_cvt_pk_bf16_f32 v82, v84, v85
    v_cvt_pk_bf16_f32 v83, v86, v87
    v_exp_f32 v89, v89
    v_exp_f32 v90, v90
    v_mfma_f32_32x32x16_bf16 v[48:63], v[100:103], v[80:83], v[48:63]
    v_exp_f32 v91, v91
    v_exp_f32 v92, v92
    v_exp_f32 v93, v93
    v_exp_f32 v94, v94
    s_add_u32 m0, s92, 109696
    s_add_u32 s67, s94, 4194304
    buffer_load_dwordx4 v3, s[28:31], s67 offen sc1 lds
    v_exp_f32 v95, v95
    v_cvt_pk_bf16_f32 v88, v88, v89
    v_cvt_pk_bf16_f32 v89, v90, v91
    v_cvt_pk_bf16_f32 v90, v92, v93
    v_cvt_pk_bf16_f32 v91, v94, v95
    s_setprio 1
    v_exp_f32 v64, v64
    v_exp_f32 v65, v65
    v_mfma_f32_32x32x16_bf16 v[48:63], v[108:111], v[88:91], v[48:63]
    ds_read_b128 v[108:111], v6 offset:11040
    ds_read_b128 v[100:103], v5 offset:13248
    v_exp_f32 v66, v66
    v_exp_f32 v67, v67
    v_exp_f32 v68, v68
    v_exp_f32 v69, v69
    v_mfma_f32_32x32x16_bf16 v[80:95], v[96:99], v[12:15], v[16:31]
    ds_read_b128 v[96:99], v4 offset:12288
    v_exp_f32 v70, v70
    v_exp_f32 v71, v71
    v_exp_f32 v72, v72
    v_cvt_pk_bf16_f32 v64, v64, v65
    v_cvt_pk_bf16_f32 v65, v66, v67
    v_cvt_pk_bf16_f32 v66, v68, v69
    v_cvt_pk_bf16_f32 v67, v70, v71
    v_exp_f32 v73, v73
    v_exp_f32 v74, v74
    v_mfma_f32_32x32x16_bf16 v[32:47], v[104:107], v[64:67], v[32:47]
    v_exp_f32 v75, v75
    v_exp_f32 v76, v76
    v_exp_f32 v77, v77
    v_exp_f32 v78, v78
    s_add_u32 s94, s93, 49152
    s_and_b32 s94, s94, 0xffff
    s_add_u32 s94, s94, s90
    s_add_u32 m0, s91, 49152
    s_add_u32 s67, s94, 2097152
    buffer_load_dwordx4 v3, s[28:31], s67 offen sc1 lds
    v_exp_f32 v79, v79
    v_cvt_pk_bf16_f32 v72, v72, v73
    v_cvt_pk_bf16_f32 v73, v74, v75
    v_cvt_pk_bf16_f32 v74, v76, v77
    v_cvt_pk_bf16_f32 v75, v78, v79
    v_exp_f32 v80, v80
    v_exp_f32 v81, v81
    s_waitcnt lgkmcnt(0)
    v_mfma_f32_32x32x16_bf16 v[32:47], v[108:111], v[72:75], v[32:47]
    v_exp_f32 v82, v82
    v_exp_f32 v83, v83
    v_exp_f32 v84, v84
    v_exp_f32 v85, v85
    v_mfma_f32_32x32x16_bf16 v[64:79], v[96:99], v[8:11], v[16:31]
    v_exp_f32 v86, v86
    v_exp_f32 v87, v87
    v_exp_f32 v88, v88
    v_cvt_pk_bf16_f32 v80, v80, v81
    v_cvt_pk_bf16_f32 v81, v82, v83
    v_cvt_pk_bf16_f32 v82, v84, v85
    v_cvt_pk_bf16_f32 v83, v86, v87
    v_exp_f32 v89, v89
    v_exp_f32 v90, v90
    v_mfma_f32_32x32x16_bf16 v[48:63], v[104:107], v[80:83], v[48:63]
    v_exp_f32 v91, v91
    v_exp_f32 v92, v92
    v_exp_f32 v93, v93
    v_exp_f32 v94, v94
    s_add_u32 m0, s92, 118528
    s_add_u32 s67, s94, 4194304
    buffer_load_dwordx4 v3, s[28:31], s67 offen sc1 lds
    v_exp_f32 v95, v95
    v_cvt_pk_bf16_f32 v88, v88, v89
    v_cvt_pk_bf16_f32 v89, v90, v91
    v_cvt_pk_bf16_f32 v90, v92, v93
    v_cvt_pk_bf16_f32 v91, v94, v95
    s_mov_b32 s98, 8388608
L_kvw:
    ds_read_b32 v180, v181 offset:4
    s_waitcnt lgkmcnt(0)
    v_cmp_ne_u32 vcc, 8, v180
    s_nop 0
    s_cbranch_vccz L_kvw_ok
    s_sleep 1
    s_sub_u32 s98, s98, 1
    s_cmp_lg_u32 s98, 0
    s_cbranch_scc1 L_kvw
L_kvw_ok:
    v_exp_f32 v64, v64
    v_exp_f32 v65, v65
    v_mfma_f32_32x32x16_bf16 v[48:63], v[108:111], v[88:91], v[48:63]
    ds_read_b128 v[108:111], v6 offset:13248
    ds_read_b128 v[104:107], v5 offset:15456
    v_exp_f32 v66, v66
    v_exp_f32 v67, v67
    v_exp_f32 v68, v68
    v_exp_f32 v69, v69
    v_mfma_f32_32x32x16_bf16 v[80:95], v[96:99], v[12:15], v[16:31]
    ds_read_b128 v[96:99], v4 offset:14336
    v_exp_f32 v70, v70
    v_exp_f32 v71, v71
    v_exp_f32 v72, v72
    v_cvt_pk_bf16_f32 v64, v64, v65
    v_cvt_pk_bf16_f32 v65, v66, v67
    v_cvt_pk_bf16_f32 v66, v68, v69
    v_cvt_pk_bf16_f32 v67, v70, v71
    v_exp_f32 v73, v73
    v_exp_f32 v74, v74
    v_mfma_f32_32x32x16_bf16 v[32:47], v[100:103], v[64:67], v[32:47]
    v_exp_f32 v75, v75
    v_exp_f32 v76, v76
    v_exp_f32 v77, v77
    v_exp_f32 v78, v78
    s_add_u32 s94, s93, 57344
    s_and_b32 s94, s94, 0xffff
    s_add_u32 s94, s94, s90
    s_add_u32 m0, s91, 57344
    s_add_u32 s67, s94, 2097152
    buffer_load_dwordx4 v3, s[28:31], s67 offen sc1 lds
    v_exp_f32 v79, v79
    v_cvt_pk_bf16_f32 v72, v72, v73
    v_cvt_pk_bf16_f32 v73, v74, v75
    v_cvt_pk_bf16_f32 v74, v76, v77
    v_cvt_pk_bf16_f32 v75, v78, v79
    v_exp_f32 v80, v80
    v_exp_f32 v81, v81
    s_waitcnt lgkmcnt(0)
    v_mfma_f32_32x32x16_bf16 v[32:47], v[108:111], v[72:75], v[32:47]
    v_exp_f32 v82, v82
    v_exp_f32 v83, v83
    v_exp_f32 v84, v84
    v_exp_f32 v85, v85
    v_mfma_f32_32x32x16_bf16 v[64:79], v[96:99], v[8:11], v[16:31]
    v_exp_f32 v86, v86
    v_exp_f32 v87, v87
    v_exp_f32 v88, v88
    v_cvt_pk_bf16_f32 v80, v80, v81
    v_cvt_pk_bf16_f32 v81, v82, v83
    v_cvt_pk_bf16_f32 v82, v84, v85
    v_cvt_pk_bf16_f32 v83, v86, v87
    v_exp_f32 v89, v89
    v_exp_f32 v90, v90
    v_mfma_f32_32x32x16_bf16 v[48:63], v[100:103], v[80:83], v[48:63]
    v_exp_f32 v91, v91
    v_exp_f32 v92, v92
    v_exp_f32 v93, v93
    v_exp_f32 v94, v94
    s_add_u32 m0, s92, 127360
    s_add_u32 s67, s94, 4194304
    buffer_load_dwordx4 v3, s[28:31], s67 offen sc1 lds
    v_exp_f32 v95, v95
    v_cvt_pk_bf16_f32 v88, v88, v89
    v_cvt_pk_bf16_f32 v89, v90, v91
    v_cvt_pk_bf16_f32 v90, v92, v93
    v_cvt_pk_bf16_f32 v91, v94, v95
    v_exp_f32 v64, v64
    v_exp_f32 v65, v65
    v_mfma_f32_32x32x16_bf16 v[48:63], v[108:111], v[88:91], v[48:63]
    ds_read_b128 v[108:111], v6 offset:15456
    ds_read_b128 v[100:103], v5 offset:17664
    v_exp_f32 v66, v66
    v_exp_f32 v67, v67
    v_exp_f32 v68, v68
    v_exp_f32 v69, v69
    v_mfma_f32_32x32x16_bf16 v[80:95], v[96:99], v[12:15], v[16:31]
    ds_read_b128 v[96:99], v4 offset:16384
    v_exp_f32 v70, v70
    v_exp_f32 v71, v71
    v_exp_f32 v72, v72
    s_add_u32 s71, s86, 0
    buffer_load_dwordx4 v[192:195], v3, s[28:31], s71 offen offset:0 sc1
    v_cvt_pk_bf16_f32 v64, v64, v65
    v_cvt_pk_bf16_f32 v65, v66, v67
    v_cvt_pk_bf16_f32 v66, v68, v69
    v_cvt_pk_bf16_f32 v67, v70, v71
    v_exp_f32 v73, v73
    v_exp_f32 v74, v74
    v_mfma_f32_32x32x16_bf16 v[32:47], v[104:107], v[64:67], v[32:47]
    v_exp_f32 v75, v75
    v_exp_f32 v76, v76
    v_exp_f32 v77, v77
    v_exp_f32 v78, v78
    v_exp_f32 v79, v79
    v_cvt_pk_bf16_f32 v72, v72, v73
    v_cvt_pk_bf16_f32 v73, v74, v75
    v_cvt_pk_bf16_f32 v74, v76, v77
    v_cvt_pk_bf16_f32 v75, v78, v79
    v_exp_f32 v80, v80
    v_exp_f32 v81, v81
    s_waitcnt lgkmcnt(0)
    v_mfma_f32_32x32x16_bf16 v[32:47], v[108:111], v[72:75], v[32:47]
    v_exp_f32 v82, v82
    v_exp_f32 v83, v83
    v_exp_f32 v84, v84
    v_exp_f32 v85, v85
    v_mfma_f32_32x32x16_bf16 v[64:79], v[96:99], v[8:11], v[16:31]
    v_exp_f32 v86, v86
    v_exp_f32 v87, v87
    v_exp_f32 v88, v88
    buffer_load_dwordx4 v[196:199], v3, s[28:31], s71 offen offset:1024 sc1
    v_cvt_pk_bf16_f32 v80, v80, v81
    v_cvt_pk_bf16_f32 v81, v82, v83
    v_cvt_pk_bf16_f32 v82, v84, v85
    v_cvt_pk_bf16_f32 v83, v86, v87
    v_exp_f32 v89, v89
    v_exp_f32 v90, v90
    v_mfma_f32_32x32x16_bf16 v[48:63], v[104:107], v[80:83], v[48:63]
    v_exp_f32 v91, v91
    v_exp_f32 v92, v92
    v_exp_f32 v93, v93
    v_exp_f32 v94, v94
    v_exp_f32 v95, v95
    v_cvt_pk_bf16_f32 v88, v88, v89
    v_cvt_pk_bf16_f32 v89, v90, v91
    v_cvt_pk_bf16_f32 v90, v92, v93
    v_cvt_pk_bf16_f32 v91, v94, v95
    v_exp_f32 v64, v64
    v_exp_f32 v65, v65
    v_mfma_f32_32x32x16_bf16 v[48:63], v[108:111], v[88:91], v[48:63]
    ds_read_b128 v[108:111], v6 offset:17664
    ds_read_b128 v[104:107], v5 offset:19872
    v_exp_f32 v66, v66
    v_exp_f32 v67, v67
    v_exp_f32 v68, v68
    v_exp_f32 v69, v69
    v_mfma_f32_32x32x16_bf16 v[80:95], v[96:99], v[12:15], v[16:31]
    ds_read_b128 v[96:99], v4 offset:18432
    v_exp_f32 v70, v70
    v_exp_f32 v71, v71
    v_exp_f32 v72, v72
    buffer_load_dwordx4 v[200:203], v3, s[28:31], s71 offen offset:2048 sc1
    v_cvt_pk_bf16_f32 v64, v64, v65
    v_cvt_pk_bf16_f32 v65, v66, v67
    v_cvt_pk_bf16_f32 v66, v68, v69
    v_cvt_pk_bf16_f32 v67, v70, v71
    v_exp_f32 v73, v73
    v_exp_f32 v74, v74
    v_mfma_f32_32x32x16_bf16 v[32:47], v[100:103], v[64:67], v[32:47]
    v_exp_f32 v75, v75
    v_exp_f32 v76, v76
    v_exp_f32 v77, v77
    v_exp_f32 v78, v78
    s_waitcnt vmcnt(3)
    s_mov_b64 exec, 1
    ds_add_u32 v181, v183 offset:12
    s_mov_b64 exec, -1
    v_exp_f32 v79, v79
    v_cvt_pk_bf16_f32 v72, v72, v73
    v_cvt_pk_bf16_f32 v73, v74, v75
    v_cvt_pk_bf16_f32 v74, v76, v77
    v_cvt_pk_bf16_f32 v75, v78, v79
    s_setprio 0
    v_exp_f32 v80, v80
    v_exp_f32 v81, v81
    s_waitcnt lgkmcnt(0)
    v_mfma_f32_32x32x16_bf16 v[32:47], v[108:111], v[72:75], v[32:47]
    v_exp_f32 v82, v82
    v_exp_f32 v83, v83
    v_exp_f32 v84, v84
    v_exp_f32 v85, v85
    v_mfma_f32_32x32x16_bf16 v[64:79], v[96:99], v[8:11], v[16:31]
    v_exp_f32 v86, v86
    v_exp_f32 v87, v87
    v_exp_f32 v88, v88
    buffer_load_dwordx4 v[204:207], v3, s[28:31], s71 offen offset:3072 sc1
    v_cvt_pk_bf16_f32 v80, v80, v81
    v_cvt_pk_bf16_f32 v81, v82, v83
    v_cvt_pk_bf16_f32 v82, v84, v85
    v_cvt_pk_bf16_f32 v83, v86, v87
    v_exp_f32 v89, v89
    v_exp_f32 v90, v90
    v_mfma_f32_32x32x16_bf16 v[48:63], v[100:103], v[80:83], v[48:63]
    v_exp_f32 v91, v91
    v_exp_f32 v92, v92
    v_exp_f32 v93, v93
    v_exp_f32 v94, v94
    v_exp_f32 v95, v95
    v_cvt_pk_bf16_f32 v88, v88, v89
    v_cvt_pk_bf16_f32 v89, v90, v91
    v_cvt_pk_bf16_f32 v90, v92, v93
    v_cvt_pk_bf16_f32 v91, v94, v95
    s_cmp_lg_u32 s3, 0
    s_cbranch_scc1 L_s2a
    buffer_load_dword v185, v187, s[28:31], s74 offen sc1
    buffer_load_dword v186, v188, s[28:31], s88 offen sc1
L_s2a:
    v_exp_f32 v64, v64
    v_exp_f32 v65, v65
    v_mfma_f32_32x32x16_bf16 v[48:63], v[108:111], v[88:91], v[48:63]
    ds_read_b128 v[108:111], v6 offset:19872
    ds_read_b128 v[100:103], v5 offset:22080
    v_exp_f32 v66, v66
    v_exp_f32 v67, v67
    v_exp_f32 v68, v68
    v_exp_f32 v69, v69
    v_mfma_f32_32x32x16_bf16 v[80:95], v[96:99], v[12:15], v[16:31]
    ds_read_b128 v[96:99], v4 offset:20480
    v_exp_f32 v70, v70
    v_exp_f32 v71, v71
    v_exp_f32 v72, v72
    s_add_u32 s71, s86, 4096
    buffer_load_dwordx4 v[208:211], v3, s[28:31], s71 offen offset:0 sc1
    v_cvt_pk_bf16_f32 v64, v64, v65
    v_cvt_pk_bf16_f32 v65, v66, v67
    v_cvt_pk_bf16_f32 v66, v68, v69
    v_cvt_pk_bf16_f32 v67, v70, v71
    v_exp_f32 v73, v73
    v_exp_f32 v74, v74
    v_mfma_f32_32x32x16_bf16 v[32:47], v[104:107], v[64:67], v[32:47]
    v_exp_f32 v75, v75
    v_exp_f32 v76, v76
    v_exp_f32 v77, v77
    v_exp_f32 v78, v78
    v_exp_f32 v79, v79
    v_cvt_pk_bf16_f32 v72, v72, v73
    v_cvt_pk_bf16_f32 v73, v74, v75
    v_cvt_pk_bf16_f32 v74, v76, v77
    v_cvt_pk_bf16_f32 v75, v78, v79
    v_exp_f32 v80, v80
    v_exp_f32 v81, v81
    s_waitcnt lgkmcnt(0)
    v_mfma_f32_32x32x16_bf16 v[32:47], v[108:111], v[72:75], v[32:47]
    v_exp_f32 v82, v82
    v_exp_f32 v83, v83
    v_exp_f32 v84, v84
    v_exp_f32 v85, v85
    v_mfma_f32_32x32x16_bf16 v[64:79], v[96:99], v[8:11], v[16:31]
    v_exp_f32 v86, v86
    v_exp_f32 v87, v87
    v_exp_f32 v88, v88
    buffer_load_dwordx4 v[212:215], v3, s[28:31], s71 offen offset:1024 sc1
    v_cvt_pk_bf16_f32 v80, v80, v81
    v_cvt_pk_bf16_f32 v81, v82, v83
    v_cvt_pk_bf16_f32 v82, v84, v85
    v_cvt_pk_bf16_f32 v83, v86, v87
    v_exp_f32 v89, v89
    v_exp_f32 v90, v90
    v_mfma_f32_32x32x16_bf16 v[48:63], v[104:107], v[80:83], v[48:63]
    v_exp_f32 v91, v91
    v_exp_f32 v92, v92
    v_exp_f32 v93, v93
    v_exp_f32 v94, v94
    v_exp_f32 v95, v95
    v_cvt_pk_bf16_f32 v88, v88, v89
    v_cvt_pk_bf16_f32 v89, v90, v91
    v_cvt_pk_bf16_f32 v90, v92, v93
    v_cvt_pk_bf16_f32 v91, v94, v95
    v_exp_f32 v64, v64
    v_exp_f32 v65, v65
    v_mfma_f32_32x32x16_bf16 v[48:63], v[108:111], v[88:91], v[48:63]
    ds_read_b128 v[108:111], v6 offset:22080
    ds_read_b128 v[104:107], v5 offset:24288
    v_exp_f32 v66, v66
    v_exp_f32 v67, v67
    v_exp_f32 v68, v68
    v_exp_f32 v69, v69
    v_mfma_f32_32x32x16_bf16 v[80:95], v[96:99], v[12:15], v[16:31]
    ds_read_b128 v[96:99], v4 offset:22528
    v_exp_f32 v70, v70
    v_exp_f32 v71, v71
    v_exp_f32 v72, v72
    buffer_load_dwordx4 v[216:219], v3, s[28:31], s71 offen offset:2048 sc1
    v_cvt_pk_bf16_f32 v64, v64, v65
    v_cvt_pk_bf16_f32 v65, v66, v67
    v_cvt_pk_bf16_f32 v66, v68, v69
    v_cvt_pk_bf16_f32 v67, v70, v71
    v_exp_f32 v73, v73
    v_exp_f32 v74, v74
    v_mfma_f32_32x32x16_bf16 v[32:47], v[100:103], v[64:67], v[32:47]
    v_exp_f32 v75, v75
    v_exp_f32 v76, v76
    v_exp_f32 v77, v77
    v_exp_f32 v78, v78
    v_exp_f32 v79, v79
    v_cvt_pk_bf16_f32 v72, v72, v73
    v_cvt_pk_bf16_f32 v73, v74, v75
    v_cvt_pk_bf16_f32 v74, v76, v77
    v_cvt_pk_bf16_f32 v75, v78, v79
    s_cmp_lg_u32 s3, 0
    s_cbranch_scc1 L_s2b
    s_waitcnt vmcnt(3)
    v_and_b32 v185, v185, v186
    v_cmp_ne_u32 vcc, 1, v185
    s_nop 0
    s_cbranch_vccz L_ps2_ok
    s_mov_b32 s98, 1048576
L_ps2:
    buffer_load_dword v185, v187, s[28:31], s74 offen sc1
    buffer_load_dword v186, v188, s[28:31], s88 offen sc1
    s_waitcnt vmcnt(0)
    v_and_b32 v185, v185, v186
    v_cmp_ne_u32 vcc, 1, v185
    s_nop 0
    s_cbranch_vccz L_ps2_ok
    s_sleep 4
    s_sub_u32 s98, s98, 1
    s_cmp_lg_u32 s98, 0
    s_cbranch_scc1 L_ps2
L_ps2_ok:
    s_mov_b64 exec, 1
    ds_add_u32 v181, v183 offset:12
    s_mov_b64 exec, -1
L_s2b:
    v_exp_f32 v80, v80
    v_exp_f32 v81, v81
    s_waitcnt lgkmcnt(0)
    v_mfma_f32_32x32x16_bf16 v[32:47], v[108:111], v[72:75], v[32:47]
    v_exp_f32 v82, v82
    v_exp_f32 v83, v83
    v_exp_f32 v84, v84
    v_exp_f32 v85, v85
    v_mfma_f32_32x32x16_bf16 v[64:79], v[96:99], v[8:11], v[16:31]
    v_exp_f32 v86, v86
    v_exp_f32 v87, v87
    v_exp_f32 v88, v88
    buffer_load_dwordx4 v[220:223], v3, s[28:31], s71 offen offset:3072 sc1
    v_cvt_pk_bf16_f32 v80, v80, v81
    v_cvt_pk_bf16_f32 v81, v82, v83
    v_cvt_pk_bf16_f32 v82, v84, v85
    v_cvt_pk_bf16_f32 v83, v86, v87
    v_exp_f32 v89, v89
    v_exp_f32 v90, v90
    v_mfma_f32_32x32x16_bf16 v[48:63], v[100:103], v[80:83], v[48:63]
    v_exp_f32 v91, v91
    v_exp_f32 v92, v92
    v_exp_f32 v93, v93
    v_exp_f32 v94, v94
    v_exp_f32 v95, v95
    v_cvt_pk_bf16_f32 v88, v88, v89
    v_cvt_pk_bf16_f32 v89, v90, v91
    v_cvt_pk_bf16_f32 v90, v92, v93
    v_cvt_pk_bf16_f32 v91, v94, v95
    s_mov_b32 s98, 8388608
L_s2w:
    ds_read_b32 v180, v181 offset:12
    s_waitcnt lgkmcnt(0)
    v_cmp_ne_u32 vcc, 9, v180
    s_nop 0
    s_cbranch_vccz L_s2w_ok
    s_sleep 1
    s_sub_u32 s98, s98, 1
    s_cmp_lg_u32 s98, 0
    s_cbranch_scc1 L_s2w
L_s2w_ok:
    s_setprio 3
    v_exp_f32 v64, v64
    v_exp_f32 v65, v65
    v_mfma_f32_32x32x16_bf16 v[48:63], v[108:111], v[88:91], v[48:63]
    ds_read_b128 v[108:111], v6 offset:24288
    ds_read_b128 v[100:103], v5 offset:26496
    v_exp_f32 v66, v66
    v_exp_f32 v67, v67
    v_exp_f32 v68, v68
    v_exp_f32 v69, v69
    v_mfma_f32_32x32x16_bf16 v[80:95], v[96:99], v[12:15], v[16:31]
    ds_read_b128 v[96:99], v4 offset:24576
    v_exp_f32 v70, v70
    v_exp_f32 v71, v71
    v_exp_f32 v72, v72
    buffer_load_dwordx4 v[148:151], v7, s[28:31], s77 offen offset:0
    buffer_load_dwordx4 v[144:147], v7, s[28:31], s76 offen offset:0 sc1
    buffer_load_dwordx4 v[152:155], v7, s[28:31], s78 offen offset:0
    v_cvt_pk_bf16_f32 v64, v64, v65
    v_cvt_pk_bf16_f32 v65, v66, v67
    v_cvt_pk_bf16_f32 v66, v68, v69
    v_cvt_pk_bf16_f32 v67, v70, v71
    v_exp_f32 v73, v73
    v_exp_f32 v74, v74
    v_mfma_f32_32x32x16_bf16 v[32:47], v[104:107], v[64:67], v[32:47]
    v_exp_f32 v75, v75
    v_exp_f32 v76, v76
    v_exp_f32 v77, v77
    v_exp_f32 v78, v78
    buffer_load_dwordx4 v[160:163], v7, s[28:31], s77 offen offset:1024
    buffer_load_dwordx4 v[156:159], v7, s[28:31], s76 offen offset:1024 sc1
    buffer_load_dwordx4 v[164:167], v7, s[28:31], s78 offen offset:1024
    v_exp_f32 v79, v79
    v_cvt_pk_bf16_f32 v72, v72, v73
    v_cvt_pk_bf16_f32 v73, v74, v75
    v_cvt_pk_bf16_f32 v74, v76, v77
    v_cvt_pk_bf16_f32 v75, v78, v79
    v_exp_f32 v80, v80
    v_exp_f32 v81, v81
    s_waitcnt lgkmcnt(0)
    v_mfma_f32_32x32x16_bf16 v[32:47], v[108:111], v[72:75], v[32:47]
    v_exp_f32 v82, v82
    v_exp_f32 v83, v83
    v_exp_f32 v84, v84
    v_exp_f32 v85, v85
    v_mfma_f32_32x32x16_bf16 v[64:79], v[96:99], v[8:11], v[16:31]
    v_exp_f32 v86, v86
    v_exp_f32 v87, v87
    v_exp_f32 v88, v88
    buffer_load_dwordx4 v[172:175], v7, s[28:31], s77 offen offset:2048
    buffer_load_dwordx4 v[168:171], v7, s[28:31], s76 offen offset:2048 sc1
    buffer_load_dwordx4 v[176:179], v7, s[28:31], s78 offen offset:2048
    v_cvt_pk_bf16_f32 v80, v80, v81
    v_cvt_pk_bf16_f32 v81, v82, v83
    v_cvt_pk_bf16_f32 v82, v84, v85
    v_cvt_pk_bf16_f32 v83, v86, v87
    v_exp_f32 v89, v89
    v_exp_f32 v90, v90
    v_mfma_f32_32x32x16_bf16 v[48:63], v[104:107], v[80:83], v[48:63]
    v_exp_f32 v91, v91
    v_exp_f32 v92, v92
    v_exp_f32 v93, v93
    v_exp_f32 v94, v94
    buffer_load_dwordx4 v[184:187], v7, s[28:31], s77 offen offset:3072
    buffer_load_dwordx4 v[180:183], v7, s[28:31], s76 offen offset:3072 sc1
    buffer_load_dwordx4 v[188:191], v7, s[28:31], s78 offen offset:3072
    v_exp_f32 v95, v95
    v_cvt_pk_bf16_f32 v88, v88, v89
    v_cvt_pk_bf16_f32 v89, v90, v91
    v_cvt_pk_bf16_f32 v90, v92, v93
    v_cvt_pk_bf16_f32 v91, v94, v95
    v_exp_f32 v64, v64
    v_exp_f32 v65, v65
    v_mfma_f32_32x32x16_bf16 v[48:63], v[108:111], v[88:91], v[48:63]
    ds_read_b128 v[108:111], v6 offset:26496
    ds_read_b128 v[104:107], v5 offset:28704
    v_exp_f32 v66, v66
    v_exp_f32 v67, v67
    v_exp_f32 v68, v68
    v_exp_f32 v69, v69
    v_mfma_f32_32x32x16_bf16 v[80:95], v[96:99], v[12:15], v[16:31]
    ds_read_b128 v[96:99], v4 offset:26624
    v_exp_f32 v70, v70
    v_exp_f32 v71, v71
    v_exp_f32 v72, v72
    s_add_u32 s71, s86, 147456
    buffer_load_dwordx4 v[224:227], v3, s[28:31], s71 offen offset:0 sc1
    v_cvt_pk_bf16_f32 v64, v64, v65
    v_cvt_pk_bf16_f32 v65, v66, v67
    v_cvt_pk_bf16_f32 v66, v68, v69
    v_cvt_pk_bf16_f32 v67, v70, v71
    v_exp_f32 v73, v73
    v_exp_f32 v74, v74
    v_mfma_f32_32x32x16_bf16 v[32:47], v[100:103], v[64:67], v[32:47]
    v_exp_f32 v75, v75
    v_exp_f32 v76, v76
    v_exp_f32 v77, v77
    v_exp_f32 v78, v78
    v_exp_f32 v79, v79
    v_cvt_pk_bf16_f32 v72, v72, v73
    v_cvt_pk_bf16_f32 v73, v74, v75
    v_cvt_pk_bf16_f32 v74, v76, v77
    v_cvt_pk_bf16_f32 v75, v78, v79
    v_exp_f32 v80, v80
    v_exp_f32 v81, v81
    s_waitcnt lgkmcnt(0)
    v_mfma_f32_32x32x16_bf16 v[32:47], v[108:111], v[72:75], v[32:47]
    v_exp_f32 v82, v82
    v_exp_f32 v83, v83
    v_exp_f32 v84, v84
    v_exp_f32 v85, v85
    v_mfma_f32_32x32x16_bf16 v[64:79], v[96:99], v[8:11], v[16:31]
    v_exp_f32 v86, v86
    v_exp_f32 v87, v87
    v_exp_f32 v88, v88
    v_cvt_pk_bf16_f32 v80, v80, v81
    v_cvt_pk_bf16_f32 v81, v82, v83
    v_cvt_pk_bf16_f32 v82, v84, v85
    v_cvt_pk_bf16_f32 v83, v86, v87
    v_exp_f32 v89, v89
    v_exp_f32 v90, v90
    v_mfma_f32_32x32x16_bf16 v[48:63], v[100:103], v[80:83], v[48:63]
    v_exp_f32 v91, v91
    v_exp_f32 v92, v92
    v_exp_f32 v93, v93
    v_exp_f32 v94, v94
    v_add_u32 v7, 4096, v7
    s_waitcnt vmcnt(10)
    v_mfma_f32_32x32x16_bf16 v[112:127], v[148:151], v[144:147], 0
    buffer_load_dwordx4 v[148:151], v7, s[28:31], s77 offen offset:0
    v_exp_f32 v95, v95
    v_cvt_pk_bf16_f32 v88, v88, v89
    v_cvt_pk_bf16_f32 v89, v90, v91
    v_cvt_pk_bf16_f32 v90, v92, v93
    v_cvt_pk_bf16_f32 v91, v94, v95
    v_exp_f32 v64, v64
    v_exp_f32 v65, v65
    v_mfma_f32_32x32x16_bf16 v[48:63], v[108:111], v[88:91], v[48:63]
    ds_read_b128 v[108:111], v6 offset:28704
    ds_read_b128 v[100:103], v5 offset:30912
    v_exp_f32 v66, v66
    v_exp_f32 v67, v67
    v_exp_f32 v68, v68
    v_exp_f32 v69, v69
    v_mfma_f32_32x32x16_bf16 v[80:95], v[96:99], v[12:15], v[16:31]
    ds_read_b128 v[96:99], v4 offset:28672
    v_exp_f32 v70, v70
    v_exp_f32 v71, v71
    v_exp_f32 v72, v72
    buffer_load_dwordx4 v[228:231], v3, s[28:31], s71 offen offset:1024 sc1
    v_cvt_pk_bf16_f32 v64, v64, v65
    v_cvt_pk_bf16_f32 v65, v66, v67
    v_cvt_pk_bf16_f32 v66, v68, v69
    v_cvt_pk_bf16_f32 v67, v70, v71
    v_exp_f32 v73, v73
    v_exp_f32 v74, v74
    v_mfma_f32_32x32x16_bf16 v[32:47], v[104:107], v[64:67], v[32:47]
    v_exp_f32 v75, v75
    v_exp_f32 v76, v76
    v_exp_f32 v77, v77
    v_exp_f32 v78, v78
    v_mfma_f32_32x32x16_bf16 v[128:143], v[152:155], v[144:147], 0
    buffer_load_dwordx4 v[144:147], v7, s[28:31], s76 offen offset:0 sc1
    buffer_load_dwordx4 v[152:155], v7, s[28:31], s78 offen offset:0
    v_exp_f32 v79, v79
    v_cvt_pk_bf16_f32 v72, v72, v73
    v_cvt_pk_bf16_f32 v73, v74, v75
    v_cvt_pk_bf16_f32 v74, v76, v77
    v_cvt_pk_bf16_f32 v75, v78, v79
    v_exp_f32 v80, v80
    v_exp_f32 v81, v81
    s_waitcnt lgkmcnt(0)
    v_mfma_f32_32x32x16_bf16 v[32:47], v[108:111], v[72:75], v[32:47]
    v_exp_f32 v82, v82
    v_exp_f32 v83, v83
    v_exp_f32 v84, v84
    v_exp_f32 v85, v85
    v_mfma_f32_32x32x16_bf16 v[64:79], v[96:99], v[8:11], v[16:31]
    v_exp_f32 v86, v86
    v_exp_f32 v87, v87
    v_exp_f32 v88, v88
    v_cvt_pk_bf16_f32 v80, v80, v81
    v_cvt_pk_bf16_f32 v81, v82, v83
    v_cvt_pk_bf16_f32 v82, v84, v85
    v_cvt_pk_bf16_f32 v83, v86, v87
    v_exp_f32 v89, v89
    v_exp_f32 v90, v90
    v_mfma_f32_32x32x16_bf16 v[48:63], v[104:107], v[80:83], v[48:63]
    v_exp_f32 v91, v91
    v_exp_f32 v92, v92
    v_exp_f32 v93, v93
    v_exp_f32 v94, v94
    s_waitcnt vmcnt(11)
    v_mfma_f32_32x32x16_bf16 v[112:127], v[160:163], v[156:159], v[112:127]
    buffer_load_dwordx4 v[160:163], v7, s[28:31], s77 offen offset:1024
    v_exp_f32 v95, v95
    v_cvt_pk_bf16_f32 v88, v88, v89
    v_cvt_pk_bf16_f32 v89, v90, v91
    v_cvt_pk_bf16_f32 v90, v92, v93
    v_cvt_pk_bf16_f32 v91, v94, v95
    v_exp_f32 v64, v64
    v_exp_f32 v65, v65
    v_mfma_f32_32x32x16_bf16 v[48:63], v[108:111], v[88:91], v[48:63]
    ds_read_b128 v[108:111], v6 offset:30912
    ds_read_b128 v[104:107], v5 offset:33120
    v_exp_f32 v66, v66
    v_exp_f32 v67, v67
    v_exp_f32 v68, v68
    v_exp_f32 v69, v69
    v_mfma_f32_32x32x16_bf16 v[80:95], v[96:99], v[12:15], v[16:31]
    ds_read_b128 v[96:99], v4 offset:30720
    v_exp_f32 v70, v70
    v_exp_f32 v71, v71
    v_exp_f32 v72, v72
    buffer_load_dwordx4 v[232:235], v3, s[28:31], s71 offen offset:2048 sc1
    v_cvt_pk_bf16_f32 v64, v64, v65
    v_cvt_pk_bf16_f32 v65, v66, v67
    v_cvt_pk_bf16_f32 v66, v68, v69
    v_cvt_pk_bf16_f32 v67, v70, v71
    v_exp_f32 v73, v73
    v_exp_f32 v74, v74
    v_mfma_f32_32x32x16_bf16 v[32:47], v[100:103], v[64:67], v[32:47]
    v_exp_f32 v75, v75
    v_exp_f32 v76, v76
    v_exp_f32 v77, v77
    v_exp_f32 v78, v78
    v_mfma_f32_32x32x16_bf16 v[128:143], v[164:167], v[156:159], v[128:143]
    buffer_load_dwordx4 v[156:159], v7, s[28:31], s76 offen offset:1024 sc1
    buffer_load_dwordx4 v[164:167], v7, s[28:31], s78 offen offset:1024
    v_exp_f32 v79, v79
    v_cvt_pk_bf16_f32 v72, v72, v73
    v_cvt_pk_bf16_f32 v73, v74, v75
    v_cvt_pk_bf16_f32 v74, v76, v77
    v_cvt_pk_bf16_f32 v75, v78, v79
    v_exp_f32 v80, v80
    v_exp_f32 v81, v81
    s_waitcnt lgkmcnt(0)
    v_mfma_f32_32x32x16_bf16 v[32:47], v[108:111], v[72:75], v[32:47]
    v_exp_f32 v82, v82
    v_exp_f32 v83, v83
    v_exp_f32 v84, v84
    v_exp_f32 v85, v85
    v_mfma_f32_32x32x16_bf16 v[64:79], v[96:99], v[8:11], v[16:31]
    v_exp_f32 v86, v86
    v_exp_f32 v87, v87
    v_exp_f32 v88, v88
    s_waitcnt vmcnt(12)
    v_mfma_f32_32x32x16_bf16 v[112:127], v[172:175], v[168:171], v[112:127]
    buffer_load_dwordx4 v[172:175], v7, s[28:31], s77 offen offset:2048
    v_cvt_pk_bf16_f32 v80, v80, v81
    v_cvt_pk_bf16_f32 v81, v82, v83
    v_cvt_pk_bf16_f32 v82, v84, v85
    v_cvt_pk_bf16_f32 v83, v86, v87
    v_exp_f32 v89, v89
    v_exp_f32 v90, v90
    v_mfma_f32_32x32x16_bf16 v[48:63], v[100:103], v[80:83], v[48:63]
    v_exp_f32 v91, v91
    v_exp_f32 v92, v92
    v_exp_f32 v93, v93
    v_exp_f32 v94, v94
    v_mfma_f32_32x32x16_bf16 v[128:143], v[176:179], v[168:171], v[128:143]
    buffer_load_dwordx4 v[168:171], v7, s[28:31], s76 offen offset:2048 sc1
    buffer_load_dwordx4 v[176:179], v7, s[28:31], s78 offen offset:2048
    v_exp_f32 v95, v95
    v_cvt_pk_bf16_f32 v88, v88, v89
    v_cvt_pk_bf16_f32 v89, v90, v91
    v_cvt_pk_bf16_f32 v90, v92, v93
    v_cvt_pk_bf16_f32 v91, v94, v95
    v_exp_f32 v64, v64
    v_exp_f32 v65, v65
    v_mfma_f32_32x32x16_bf16 v[48:63], v[108:111], v[88:91], v[48:63]
    ds_read_b128 v[108:111], v6 offset:33120
    ds_read_b128 v[100:103], v5 offset:35328
    v_exp_f32 v66, v66
    v_exp_f32 v67, v67
    v_exp_f32 v68, v68
    v_exp_f32 v69, v69
    v_mfma_f32_32x32x16_bf16 v[80:95], v[96:99], v[12:15], v[16:31]
    ds_read_b128 v[96:99], v4 offset:32768
    v_exp_f32 v70, v70
    v_exp_f32 v71, v71
    v_exp_f32 v72, v72
    buffer_load_dwordx4 v[236:239], v3, s[28:31], s71 offen offset:3072 sc1
    v_cvt_pk_bf16_f32 v64, v64, v65
    v_cvt_pk_bf16_f32 v65, v66, v67
    v_cvt_pk_bf16_f32 v66, v68, v69
    v_cvt_pk_bf16_f32 v67, v70, v71
    v_exp_f32 v73, v73
    v_exp_f32 v74, v74
    v_mfma_f32_32x32x16_bf16 v[32:47], v[104:107], v[64:67], v[32:47]
    v_exp_f32 v75, v75
    v_exp_f32 v76, v76
    v_exp_f32 v77, v77
    v_exp_f32 v78, v78
    s_waitcnt vmcnt(13)
    v_mfma_f32_32x32x16_bf16 v[112:127], v[184:187], v[180:183], v[112:127]
    buffer_load_dwordx4 v[184:187], v7, s[28:31], s77 offen offset:3072
    v_exp_f32 v79, v79
    v_cvt_pk_bf16_f32 v72, v72, v73
    v_cvt_pk_bf16_f32 v73, v74, v75
    v_cvt_pk_bf16_f32 v74, v76, v77
    v_cvt_pk_bf16_f32 v75, v78, v79
    v_exp_f32 v80, v80
    v_exp_f32 v81, v81
    s_waitcnt lgkmcnt(0)
    v_mfma_f32_32x32x16_bf16 v[32:47], v[108:111], v[72:75], v[32:47]
    v_exp_f32 v82, v82
    v_exp_f32 v83, v83
    v_exp_f32 v84, v84
    v_exp_f32 v85, v85
    v_mfma_f32_32x32x16_bf16 v[64:79], v[96:99], v[8:11], v[16:31]
    v_exp_f32 v86, v86
    v_exp_f32 v87, v87
    v_exp_f32 v88, v88
    v_cvt_pk_bf16_f32 v80, v80, v81
    v_cvt_pk_bf16_f32 v81, v82, v83
    v_cvt_pk_bf16_f32 v82, v84, v85
    v_cvt_pk_bf16_f32 v83, v86, v87
    v_exp_f32 v89, v89
    v_exp_f32 v90, v90
    v_mfma_f32_32x32x16_bf16 v[48:63], v[104:107], v[80:83], v[48:63]
    v_exp_f32 v91, v91
    v_exp_f32 v92, v92
    v_exp_f32 v93, v93
    v_exp_f32 v94, v94
    v_mfma_f32_32x32x16_bf16 v[128:143], v[188:191], v[180:183], v[128:143]
    buffer_load_dwordx4 v[180:183], v7, s[28:31], s76 offen offset:3072 sc1
    buffer_load_dwordx4 v[188:191], v7, s[28:31], s78 offen offset:3072
    v_exp_f32 v95, v95
    v_cvt_pk_bf16_f32 v88, v88, v89
    v_cvt_pk_bf16_f32 v89, v90, v91
    v_cvt_pk_bf16_f32 v90, v92, v93
    v_cvt_pk_bf16_f32 v91, v94, v95
    v_add_u32 v4, 32768, v4
    v_add_u32 v5, 35328, v5
    v_add_u32 v6, 35328, v6
    v_exp_f32 v64, v64
    v_exp_f32 v65, v65
    v_mfma_f32_32x32x16_bf16 v[48:63], v[108:111], v[88:91], v[48:63]
    ds_read_b128 v[108:111], v6 offset:0
    ds_read_b128 v[104:107], v5 offset:2208
    v_exp_f32 v66, v66
    v_exp_f32 v67, v67
    v_exp_f32 v68, v68
    v_exp_f32 v69, v69
    v_mfma_f32_32x32x16_bf16 v[80:95], v[96:99], v[12:15], v[16:31]
    ds_read_b128 v[96:99], v4 offset:2048
    v_exp_f32 v70, v70
    v_exp_f32 v71, v71
    v_exp_f32 v72, v72
    s_add_u32 s71, s86, 151552
    buffer_load_dwordx4 v[240:243], v3, s[28:31], s71 offen offset:0 sc1
    v_cvt_pk_bf16_f32 v64, v64, v65
    v_cvt_pk_bf16_f32 v65, v66, v67
    v_cvt_pk_bf16_f32 v66, v68, v69
    v_cvt_pk_bf16_f32 v67, v70, v71
    v_exp_f32 v73, v73
    v_exp_f32 v74, v74
    v_mfma_f32_32x32x16_bf16 v[32:47], v[100:103], v[64:67], v[32:47]
    v_exp_f32 v75, v75
    v_exp_f32 v76, v76
    v_exp_f32 v77, v77
    v_exp_f32 v78, v78
    v_add_u32 v7, 4096, v7
    s_waitcnt vmcnt(12)
    v_mfma_f32_32x32x16_bf16 v[112:127], v[148:151], v[144:147], v[112:127]
    buffer_load_dwordx4 v[148:151], v7, s[28:31], s77 offen offset:0
    v_exp_f32 v79, v79
    v_cvt_pk_bf16_f32 v72, v72, v73
    v_cvt_pk_bf16_f32 v73, v74, v75
    v_cvt_pk_bf16_f32 v74, v76, v77
    v_cvt_pk_bf16_f32 v75, v78, v79
    v_exp_f32 v80, v80
    v_exp_f32 v81, v81
    s_waitcnt lgkmcnt(0)
    v_mfma_f32_32x32x16_bf16 v[32:47], v[108:111], v[72:75], v[32:47]
    v_exp_f32 v82, v82
    v_exp_f32 v83, v83
    v_exp_f32 v84, v84
    v_exp_f32 v85, v85
    v_mfma_f32_32x32x16_bf16 v[64:79], v[96:99], v[8:11], v[16:31]
    v_exp_f32 v86, v86
    v_exp_f32 v87, v87
    v_exp_f32 v88, v88
    v_mfma_f32_32x32x16_bf16 v[128:143], v[152:155], v[144:147], v[128:143]
    buffer_load_dwordx4 v[144:147], v7, s[28:31], s76 offen offset:0 sc1
    buffer_load_dwordx4 v[152:155], v7, s[28:31], s78 offen offset:0
    v_cvt_pk_bf16_f32 v80, v80, v81
    v_cvt_pk_bf16_f32 v81, v82, v83
    v_cvt_pk_bf16_f32 v82, v84, v85
    v_cvt_pk_bf16_f32 v83, v86, v87
    v_exp_f32 v89, v89
    v_exp_f32 v90, v90
    v_mfma_f32_32x32x16_bf16 v[48:63], v[100:103], v[80:83], v[48:63]
    v_exp_f32 v91, v91
    v_exp_f32 v92, v92
    v_exp_f32 v93, v93
    v_exp_f32 v94, v94
    s_waitcnt vmcnt(11)
    v_mfma_f32_32x32x16_bf16 v[112:127], v[160:163], v[156:159], v[112:127]
    buffer_load_dwordx4 v[160:163], v7, s[28:31], s77 offen offset:1024
    v_exp_f32 v95, v95
    v_cvt_pk_bf16_f32 v88, v88, v89
    v_cvt_pk_bf16_f32 v89, v90, v91
    v_cvt_pk_bf16_f32 v90, v92, v93
    v_cvt_pk_bf16_f32 v91, v94, v95
    v_exp_f32 v64, v64
    v_exp_f32 v65, v65
    v_mfma_f32_32x32x16_bf16 v[48:63], v[108:111], v[88:91], v[48:63]
    ds_read_b128 v[108:111], v6 offset:2208
    ds_read_b128 v[100:103], v5 offset:4416
    v_exp_f32 v66, v66
    v_exp_f32 v67, v67
    v_exp_f32 v68, v68
    v_exp_f32 v69, v69
    v_mfma_f32_32x32x16_bf16 v[80:95], v[96:99], v[12:15], v[16:31]
    ds_read_b128 v[96:99], v4 offset:4096
    v_exp_f32 v70, v70
    v_exp_f32 v71, v71
    v_exp_f32 v72, v72
    buffer_load_dwordx4 v[244:247], v3, s[28:31], s71 offen offset:1024 sc1
    v_cvt_pk_bf16_f32 v64, v64, v65
    v_cvt_pk_bf16_f32 v65, v66, v67
    v_cvt_pk_bf16_f32 v66, v68, v69
    v_cvt_pk_bf16_f32 v67, v70, v71
    v_exp_f32 v73, v73
    v_exp_f32 v74, v74
    v_mfma_f32_32x32x16_bf16 v[32:47], v[104:107], v[64:67], v[32:47]
    v_exp_f32 v75, v75
    v_exp_f32 v76, v76
    v_exp_f32 v77, v77
    v_exp_f32 v78, v78
    v_mfma_f32_32x32x16_bf16 v[128:143], v[164:167], v[156:159], v[128:143]
    buffer_load_dwordx4 v[156:159], v7, s[28:31], s76 offen offset:1024 sc1
    buffer_load_dwordx4 v[164:167], v7, s[28:31], s78 offen offset:1024
    v_exp_f32 v79, v79
    v_cvt_pk_bf16_f32 v72, v72, v73
    v_cvt_pk_bf16_f32 v73, v74, v75
    v_cvt_pk_bf16_f32 v74, v76, v77
    v_cvt_pk_bf16_f32 v75, v78, v79
    v_exp_f32 v80, v80
    v_exp_f32 v81, v81
    s_waitcnt lgkmcnt(0)
    v_mfma_f32_32x32x16_bf16 v[32:47], v[108:111], v[72:75], v[32:47]
    v_exp_f32 v82, v82
    v_exp_f32 v83, v83
    v_exp_f32 v84, v84
    v_exp_f32 v85, v85
    v_mfma_f32_32x32x16_bf16 v[64:79], v[96:99], v[8:11], v[16:31]
    v_exp_f32 v86, v86
    v_exp_f32 v87, v87
    v_exp_f32 v88, v88
    v_cvt_pk_bf16_f32 v80, v80, v81
    v_cvt_pk_bf16_f32 v81, v82, v83
    v_cvt_pk_bf16_f32 v82, v84, v85
    v_cvt_pk_bf16_f32 v83, v86, v87
    v_exp_f32 v89, v89
    v_exp_f32 v90, v90
    v_mfma_f32_32x32x16_bf16 v[48:63], v[104:107], v[80:83], v[48:63]
    v_exp_f32 v91, v91
    v_exp_f32 v92, v92
    v_exp_f32 v93, v93
    v_exp_f32 v94, v94
    s_waitcnt vmcnt(12)
    v_mfma_f32_32x32x16_bf16 v[112:127], v[172:175], v[168:171], v[112:127]
    buffer_load_dwordx4 v[172:175], v7, s[28:31], s77 offen offset:2048
    v_exp_f32 v95, v95
    v_cvt_pk_bf16_f32 v88, v88, v89
    v_cvt_pk_bf16_f32 v89, v90, v91
    v_cvt_pk_bf16_f32 v90, v92, v93
    v_cvt_pk_bf16_f32 v91, v94, v95
    v_exp_f32 v64, v64
    v_exp_f32 v65, v65
    v_mfma_f32_32x32x16_bf16 v[48:63], v[108:111], v[88:91], v[48:63]
    ds_read_b128 v[108:111], v6 offset:4416
    ds_read_b128 v[104:107], v5 offset:6624
    v_exp_f32 v66, v66
    v_exp_f32 v67, v67
    v_exp_f32 v68, v68
    v_exp_f32 v69, v69
    v_mfma_f32_32x32x16_bf16 v[80:95], v[96:99], v[12:15], v[16:31]
    ds_read_b128 v[96:99], v4 offset:6144
    v_exp_f32 v70, v70
    v_exp_f32 v71, v71
    v_exp_f32 v72, v72
    buffer_load_dwordx4 v[248:251], v3, s[28:31], s71 offen offset:2048 sc1
    v_cvt_pk_bf16_f32 v64, v64, v65
    v_cvt_pk_bf16_f32 v65, v66, v67
    v_cvt_pk_bf16_f32 v66, v68, v69
    v_cvt_pk_bf16_f32 v67, v70, v71
    v_exp_f32 v73, v73
    v_exp_f32 v74, v74
    v_mfma_f32_32x32x16_bf16 v[32:47], v[100:103], v[64:67], v[32:47]
    v_exp_f32 v75, v75
    v_exp_f32 v76, v76
    v_exp_f32 v77, v77
    v_exp_f32 v78, v78
    v_mfma_f32_32x32x16_bf16 v[128:143], v[176:179], v[168:171], v[128:143]
    buffer_load_dwordx4 v[168:171], v7, s[28:31], s76 offen offset:2048 sc1
    buffer_load_dwordx4 v[176:179], v7, s[28:31], s78 offen offset:2048
    v_exp_f32 v79, v79
    v_cvt_pk_bf16_f32 v72, v72, v73
    v_cvt_pk_bf16_f32 v73, v74, v75
    v_cvt_pk_bf16_f32 v74, v76, v77
    v_cvt_pk_bf16_f32 v75, v78, v79
    v_exp_f32 v80, v80
    v_exp_f32 v81, v81
    s_waitcnt lgkmcnt(0)
    v_mfma_f32_32x32x16_bf16 v[32:47], v[108:111], v[72:75], v[32:47]
    v_exp_f32 v82, v82
    v_exp_f32 v83, v83
    v_exp_f32 v84, v84
    v_exp_f32 v85, v85
    v_mfma_f32_32x32x16_bf16 v[64:79], v[96:99], v[8:11], v[16:31]
    v_exp_f32 v86, v86
    v_exp_f32 v87, v87
    v_exp_f32 v88, v88
    s_waitcnt vmcnt(12)
    v_mfma_f32_32x32x16_bf16 v[112:127], v[184:187], v[180:183], v[112:127]
    buffer_load_dwordx4 v[184:187], v7, s[28:31], s77 offen offset:3072
    v_cvt_pk_bf16_f32 v80, v80, v81
    v_cvt_pk_bf16_f32 v81, v82, v83
    v_cvt_pk_bf16_f32 v82, v84, v85
    v_cvt_pk_bf16_f32 v83, v86, v87
    v_exp_f32 v89, v89
    v_exp_f32 v90, v90
    v_mfma_f32_32x32x16_bf16 v[48:63], v[100:103], v[80:83], v[48:63]
    v_exp_f32 v91, v91
    v_exp_f32 v92, v92
    v_exp_f32 v93, v93
    v_exp_f32 v94, v94
    v_mfma_f32_32x32x16_bf16 v[128:143], v[188:191], v[180:183], v[128:143]
    buffer_load_dwordx4 v[180:183], v7, s[28:31], s76 offen offset:3072 sc1
    buffer_load_dwordx4 v[188:191], v7, s[28:31], s78 offen offset:3072
    v_exp_f32 v95, v95
    v_cvt_pk_bf16_f32 v88, v88, v89
    v_cvt_pk_bf16_f32 v89, v90, v91
    v_cvt_pk_bf16_f32 v90, v92, v93
    v_cvt_pk_bf16_f32 v91, v94, v95
    v_exp_f32 v64, v64
    v_exp_f32 v65, v65
    v_mfma_f32_32x32x16_bf16 v[48:63], v[108:111], v[88:91], v[48:63]
    ds_read_b128 v[108:111], v6 offset:6624
    ds_read_b128 v[100:103], v5 offset:8832
    v_exp_f32 v66, v66
    v_exp_f32 v67, v67
    v_exp_f32 v68, v68
    v_exp_f32 v69, v69
    v_mfma_f32_32x32x16_bf16 v[80:95], v[96:99], v[12:15], v[16:31]
    ds_read_b128 v[96:99], v4 offset:8192
    v_exp_f32 v70, v70
    v_exp_f32 v71, v71
    v_exp_f32 v72, v72
    buffer_load_dwordx4 v[252:255], v3, s[28:31], s71 offen offset:3072 sc1
    v_cvt_pk_bf16_f32 v64, v64, v65
    v_cvt_pk_bf16_f32 v65, v66, v67
    v_cvt_pk_bf16_f32 v66, v68, v69
    v_cvt_pk_bf16_f32 v67, v70, v71
    v_exp_f32 v73, v73
    v_exp_f32 v74, v74
    v_mfma_f32_32x32x16_bf16 v[32:47], v[104:107], v[64:67], v[32:47]
    v_exp_f32 v75, v75
    v_exp_f32 v76, v76
    v_exp_f32 v77, v77
    v_exp_f32 v78, v78
    v_add_u32 v7, 4096, v7
    s_waitcnt vmcnt(12)
    v_mfma_f32_32x32x16_bf16 v[112:127], v[148:151], v[144:147], v[112:127]
    buffer_load_dwordx4 v[148:151], v7, s[28:31], s77 offen offset:0
    v_exp_f32 v79, v79
    v_cvt_pk_bf16_f32 v72, v72, v73
    v_cvt_pk_bf16_f32 v73, v74, v75
    v_cvt_pk_bf16_f32 v74, v76, v77
    v_cvt_pk_bf16_f32 v75, v78, v79
    v_exp_f32 v80, v80
    v_exp_f32 v81, v81
    s_waitcnt lgkmcnt(0)
    v_mfma_f32_32x32x16_bf16 v[32:47], v[108:111], v[72:75], v[32:47]
    v_exp_f32 v82, v82
    v_exp_f32 v83, v83
    v_exp_f32 v84, v84
    v_exp_f32 v85, v85
    v_mfma_f32_32x32x16_bf16 v[64:79], v[96:99], v[8:11], v[16:31]
    v_exp_f32 v86, v86
    v_exp_f32 v87, v87
    v_exp_f32 v88, v88
    v_cvt_pk_bf16_f32 v80, v80, v81
    v_cvt_pk_bf16_f32 v81, v82, v83
    v_cvt_pk_bf16_f32 v82, v84, v85
    v_cvt_pk_bf16_f32 v83, v86, v87
    v_exp_f32 v89, v89
    v_exp_f32 v90, v90
    v_mfma_f32_32x32x16_bf16 v[48:63], v[104:107], v[80:83], v[48:63]
    v_exp_f32 v91, v91
    v_exp_f32 v92, v92
    v_exp_f32 v93, v93
    v_exp_f32 v94, v94
    v_mfma_f32_32x32x16_bf16 v[128:143], v[152:155], v[144:147], v[128:143]
    buffer_load_dwordx4 v[144:147], v7, s[28:31], s76 offen offset:0 sc1
    buffer_load_dwordx4 v[152:155], v7, s[28:31], s78 offen offset:0
    v_exp_f32 v95, v95
    v_cvt_pk_bf16_f32 v88, v88, v89
    v_cvt_pk_bf16_f32 v89, v90, v91
    v_cvt_pk_bf16_f32 v90, v92, v93
    v_cvt_pk_bf16_f32 v91, v94, v95
    v_exp_f32 v64, v64
    v_exp_f32 v65, v65
    v_mfma_f32_32x32x16_bf16 v[48:63], v[108:111], v[88:91], v[48:63]
    ds_read_b128 v[108:111], v6 offset:8832
    ds_read_b128 v[104:107], v5 offset:11040
    v_exp_f32 v66, v66
    v_exp_f32 v67, v67
    v_exp_f32 v68, v68
    v_exp_f32 v69, v69
    v_mfma_f32_32x32x16_bf16 v[80:95], v[96:99], v[12:15], v[16:31]
    ds_read_b128 v[96:99], v4 offset:10240
    v_exp_f32 v70, v70
    v_exp_f32 v71, v71
    v_exp_f32 v72, v72
    v_cvt_pk_bf16_f32 v64, v64, v65
    v_cvt_pk_bf16_f32 v65, v66, v67
    v_cvt_pk_bf16_f32 v66, v68, v69
    v_cvt_pk_bf16_f32 v67, v70, v71
    v_exp_f32 v73, v73
    v_exp_f32 v74, v74
    v_mfma_f32_32x32x16_bf16 v[32:47], v[100:103], v[64:67], v[32:47]
    v_exp_f32 v75, v75
    v_exp_f32 v76, v76
    v_exp_f32 v77, v77
    v_exp_f32 v78, v78
    s_waitcnt vmcnt(11)
    v_mfma_f32_32x32x16_bf16 v[112:127], v[160:163], v[156:159], v[112:127]
    buffer_load_dwordx4 v[160:163], v7, s[28:31], s77 offen offset:1024
    v_exp_f32 v79, v79
    v_cvt_pk_bf16_f32 v72, v72, v73
    v_cvt_pk_bf16_f32 v73, v74, v75
    v_cvt_pk_bf16_f32 v74, v76, v77
    v_cvt_pk_bf16_f32 v75, v78, v79
    v_exp_f32 v80, v80
    v_exp_f32 v81, v81
    s_waitcnt lgkmcnt(0)
    v_mfma_f32_32x32x16_bf16 v[32:47], v[108:111], v[72:75], v[32:47]
    v_exp_f32 v82, v82
    v_exp_f32 v83, v83
    v_exp_f32 v84, v84
    v_exp_f32 v85, v85
    v_mfma_f32_32x32x16_bf16 v[64:79], v[96:99], v[8:11], v[16:31]
    v_exp_f32 v86, v86
    v_exp_f32 v87, v87
    v_exp_f32 v88, v88
    v_cvt_pk_bf16_f32 v80, v80, v81
    v_cvt_pk_bf16_f32 v81, v82, v83
    v_cvt_pk_bf16_f32 v82, v84, v85
    v_cvt_pk_bf16_f32 v83, v86, v87
    v_exp_f32 v89, v89
    v_exp_f32 v90, v90
    v_mfma_f32_32x32x16_bf16 v[48:63], v[100:103], v[80:83], v[48:63]
    v_exp_f32 v91, v91
    v_exp_f32 v92, v92
    v_exp_f32 v93, v93
    v_exp_f32 v94, v94
    v_mfma_f32_32x32x16_bf16 v[128:143], v[164:167], v[156:159], v[128:143]
    buffer_load_dwordx4 v[156:159], v7, s[28:31], s76 offen offset:1024 sc1
    buffer_load_dwordx4 v[164:167], v7, s[28:31], s78 offen offset:1024
    v_exp_f32 v95, v95
    v_cvt_pk_bf16_f32 v88, v88, v89
    v_cvt_pk_bf16_f32 v89, v90, v91
    v_cvt_pk_bf16_f32 v90, v92, v93
    v_cvt_pk_bf16_f32 v91, v94, v95
    s_setprio 2
    v_exp_f32 v64, v64
    v_exp_f32 v65, v65
    v_mfma_f32_32x32x16_bf16 v[48:63], v[108:111], v[88:91], v[48:63]
    ds_read_b128 v[108:111], v6 offset:11040
    ds_read_b128 v[100:103], v5 offset:13248
    v_exp_f32 v66, v66
    v_exp_f32 v67, v67
    v_exp_f32 v68, v68
    v_exp_f32 v69, v69
    v_mfma_f32_32x32x16_bf16 v[80:95], v[96:99], v[12:15], v[16:31]
    ds_read_b128 v[96:99], v4 offset:12288
    v_exp_f32 v70, v70
    v_exp_f32 v71, v71
    v_exp_f32 v72, v72
    s_waitcnt vmcnt(10)
    v_mfma_f32_32x32x16_bf16 v[112:127], v[172:175], v[168:171], v[112:127]
    buffer_load_dwordx4 v[172:175], v7, s[28:31], s77 offen offset:2048
    v_cvt_pk_bf16_f32 v64, v64, v65
    v_cvt_pk_bf16_f32 v65, v66, v67
    v_cvt_pk_bf16_f32 v66, v68, v69
    v_cvt_pk_bf16_f32 v67, v70, v71
    v_exp_f32 v73, v73
    v_exp_f32 v74, v74
    v_mfma_f32_32x32x16_bf16 v[32:47], v[104:107], v[64:67], v[32:47]
    v_exp_f32 v75, v75
    v_exp_f32 v76, v76
    v_exp_f32 v77, v77
    v_exp_f32 v78, v78
    v_mfma_f32_32x32x16_bf16 v[128:143], v[176:179], v[168:171], v[128:143]
    buffer_load_dwordx4 v[168:171], v7, s[28:31], s76 offen offset:2048 sc1
    buffer_load_dwordx4 v[176:179], v7, s[28:31], s78 offen offset:2048
    v_exp_f32 v79, v79
    v_cvt_pk_bf16_f32 v72, v72, v73
    v_cvt_pk_bf16_f32 v73, v74, v75
    v_cvt_pk_bf16_f32 v74, v76, v77
    v_cvt_pk_bf16_f32 v75, v78, v79
    v_exp_f32 v80, v80
    v_exp_f32 v81, v81
    s_waitcnt lgkmcnt(0)
    v_mfma_f32_32x32x16_bf16 v[32:47], v[108:111], v[72:75], v[32:47]
    v_exp_f32 v82, v82
    v_exp_f32 v83, v83
    v_exp_f32 v84, v84
    v_exp_f32 v85, v85
    v_mfma_f32_32x32x16_bf16 v[64:79], v[96:99], v[8:11], v[16:31]
    v_exp_f32 v86, v86
    v_exp_f32 v87, v87
    v_exp_f32 v88, v88
    v_cvt_pk_bf16_f32 v80, v80, v81
    v_cvt_pk_bf16_f32 v81, v82, v83
    v_cvt_pk_bf16_f32 v82, v84, v85
    v_cvt_pk_bf16_f32 v83, v86, v87
    v_exp_f32 v89, v89
    v_exp_f32 v90, v90
    v_mfma_f32_32x32x16_bf16 v[48:63], v[104:107], v[80:83], v[48:63]
    v_exp_f32 v91, v91
    v_exp_f32 v92, v92
    v_exp_f32 v93, v93
    v_exp_f32 v94, v94
    s_waitcnt vmcnt(10)
    v_mfma_f32_32x32x16_bf16 v[112:127], v[184:187], v[180:183], v[112:127]
    buffer_load_dwordx4 v[184:187], v7, s[28:31], s77 offen offset:3072
    v_exp_f32 v95, v95
    v_cvt_pk_bf16_f32 v88, v88, v89
    v_cvt_pk_bf16_f32 v89, v90, v91
    v_cvt_pk_bf16_f32 v90, v92, v93
    v_cvt_pk_bf16_f32 v91, v94, v95
    v_exp_f32 v64, v64
    v_exp_f32 v65, v65
    v_mfma_f32_32x32x16_bf16 v[48:63], v[108:111], v[88:91], v[48:63]
    ds_read_b128 v[108:111], v6 offset:13248
    ds_read_b128 v[104:107], v5 offset:15456
    v_exp_f32 v66, v66
    v_exp_f32 v67, v67
    v_exp_f32 v68, v68
    v_exp_f32 v69, v69
    v_mfma_f32_32x32x16_bf16 v[80:95], v[96:99], v[12:15], v[16:31]
    ds_read_b128 v[96:99], v4 offset:14336
    v_exp_f32 v70, v70
    v_exp_f32 v71, v71
    v_exp_f32 v72, v72
    v_cvt_pk_bf16_f32 v64, v64, v65
    v_cvt_pk_bf16_f32 v65, v66, v67
    v_cvt_pk_bf16_f32 v66, v68, v69
    v_cvt_pk_bf16_f32 v67, v70, v71
    v_exp_f32 v73, v73
    v_exp_f32 v74, v74
    v_mfma_f32_32x32x16_bf16 v[32:47], v[100:103], v[64:67], v[32:47]
    v_exp_f32 v75, v75
    v_exp_f32 v76, v76
    v_exp_f32 v77, v77
    v_exp_f32 v78, v78
    v_mfma_f32_32x32x16_bf16 v[128:143], v[188:191], v[180:183], v[128:143]
    buffer_load_dwordx4 v[180:183], v7, s[28:31], s76 offen offset:3072 sc1
    buffer_load_dwordx4 v[188:191], v7, s[28:31], s78 offen offset:3072
    v_exp_f32 v79, v79
    v_cvt_pk_bf16_f32 v72, v72, v73
    v_cvt_pk_bf16_f32 v73, v74, v75
    v_cvt_pk_bf16_f32 v74, v76, v77
    v_cvt_pk_bf16_f32 v75, v78, v79
    v_exp_f32 v80, v80
    v_exp_f32 v81, v81
    s_waitcnt lgkmcnt(0)
    v_mfma_f32_32x32x16_bf16 v[32:47], v[108:111], v[72:75], v[32:47]
    v_exp_f32 v82, v82
    v_exp_f32 v83, v83
    v_exp_f32 v84, v84
    v_exp_f32 v85, v85
    v_mfma_f32_32x32x16_bf16 v[64:79], v[96:99], v[8:11], v[16:31]
    v_exp_f32 v86, v86
    v_exp_f32 v87, v87
    v_exp_f32 v88, v88
    v_cvt_pk_bf16_f32 v80, v80, v81
    v_cvt_pk_bf16_f32 v81, v82, v83
    v_cvt_pk_bf16_f32 v82, v84, v85
    v_cvt_pk_bf16_f32 v83, v86, v87
    v_exp_f32 v89, v89
    v_exp_f32 v90, v90
    v_mfma_f32_32x32x16_bf16 v[48:63], v[100:103], v[80:83], v[48:63]
    v_exp_f32 v91, v91
    v_exp_f32 v92, v92
    v_exp_f32 v93, v93
    v_exp_f32 v94, v94
    v_add_u32 v7, 4096, v7
    s_waitcnt vmcnt(9)
    v_mfma_f32_32x32x16_bf16 v[112:127], v[148:151], v[144:147], v[112:127]
    buffer_load_dwordx4 v[148:151], v7, s[28:31], s77 offen offset:0
    v_exp_f32 v95, v95
    v_cvt_pk_bf16_f32 v88, v88, v89
    v_cvt_pk_bf16_f32 v89, v90, v91
    v_cvt_pk_bf16_f32 v90, v92, v93
    v_cvt_pk_bf16_f32 v91, v94, v95
    v_exp_f32 v64, v64
    v_exp_f32 v65, v65
    v_mfma_f32_32x32x16_bf16 v[48:63], v[108:111], v[88:91], v[48:63]
    ds_read_b128 v[108:111], v6 offset:15456
    ds_read_b128 v[100:103], v5 offset:17664
    v_exp_f32 v66, v66
    v_exp_f32 v67, v67
    v_exp_f32 v68, v68
    v_exp_f32 v69, v69
    v_mfma_f32_32x32x16_bf16 v[80:95], v[96:99], v[12:15], v[16:31]
    ds_read_b128 v[96:99], v4 offset:16384
    v_exp_f32 v70, v70
    v_exp_f32 v71, v71
    v_exp_f32 v72, v72
    v_mfma_f32_32x32x16_bf16 v[128:143], v[152:155], v[144:147], v[128:143]
    buffer_load_dwordx4 v[144:147], v7, s[28:31], s76 offen offset:0 sc1
    buffer_load_dwordx4 v[152:155], v7, s[28:31], s78 offen offset:0
    v_cvt_pk_bf16_f32 v64, v64, v65
    v_cvt_pk_bf16_f32 v65, v66, v67
    v_cvt_pk_bf16_f32 v66, v68, v69
    v_cvt_pk_bf16_f32 v67, v70, v71
    v_exp_f32 v73, v73
    v_exp_f32 v74, v74
    v_mfma_f32_32x32x16_bf16 v[32:47], v[104:107], v[64:67], v[32:47]
    v_exp_f32 v75, v75
    v_exp_f32 v76, v76
    v_exp_f32 v77, v77
    v_exp_f32 v78, v78
    s_waitcnt vmcnt(9)
    v_mfma_f32_32x32x16_bf16 v[112:127], v[160:163], v[156:159], v[112:127]
    buffer_load_dwordx4 v[160:163], v7, s[28:31], s77 offen offset:1024
    v_exp_f32 v79, v79
    v_cvt_pk_bf16_f32 v72, v72, v73
    v_cvt_pk_bf16_f32 v73, v74, v75
    v_cvt_pk_bf16_f32 v74, v76, v77
    v_cvt_pk_bf16_f32 v75, v78, v79
    v_exp_f32 v80, v80
    v_exp_f32 v81, v81
    s_waitcnt lgkmcnt(0)
    v_mfma_f32_32x32x16_bf16 v[32:47], v[108:111], v[72:75], v[32:47]
    v_exp_f32 v82, v82
    v_exp_f32 v83, v83
    v_exp_f32 v84, v84
    v_exp_f32 v85, v85
    v_mfma_f32_32x32x16_bf16 v[64:79], v[96:99], v[8:11], v[16:31]
    v_exp_f32 v86, v86
    v_exp_f32 v87, v87
    v_exp_f32 v88, v88
    v_cvt_pk_bf16_f32 v80, v80, v81
    v_cvt_pk_bf16_f32 v81, v82, v83
    v_cvt_pk_bf16_f32 v82, v84, v85
    v_cvt_pk_bf16_f32 v83, v86, v87
    v_exp_f32 v89, v89
    v_exp_f32 v90, v90
    v_mfma_f32_32x32x16_bf16 v[48:63], v[104:107], v[80:83], v[48:63]
    v_exp_f32 v91, v91
    v_exp_f32 v92, v92
    v_exp_f32 v93, v93
    v_exp_f32 v94, v94
    v_mfma_f32_32x32x16_bf16 v[128:143], v[164:167], v[156:159], v[128:143]
    buffer_load_dwordx4 v[156:159], v7, s[28:31], s76 offen offset:1024 sc1
    buffer_load_dwordx4 v[164:167], v7, s[28:31], s78 offen offset:1024
    v_exp_f32 v95, v95
    v_cvt_pk_bf16_f32 v88, v88, v89
    v_cvt_pk_bf16_f32 v89, v90, v91
    v_cvt_pk_bf16_f32 v90, v92, v93
    v_cvt_pk_bf16_f32 v91, v94, v95
    v_exp_f32 v64, v64
    v_exp_f32 v65, v65
    v_mfma_f32_32x32x16_bf16 v[48:63], v[108:111], v[88:91], v[48:63]
    ds_read_b128 v[108:111], v6 offset:17664
    ds_read_b128 v[104:107], v5 offset:19872
    v_exp_f32 v66, v66
    v_exp_f32 v67, v67
    v_exp_f32 v68, v68
    v_exp_f32 v69, v69
    v_mfma_f32_32x32x16_bf16 v[80:95], v[96:99], v[12:15], v[16:31]
    ds_read_b128 v[96:99], v4 offset:18432
    v_exp_f32 v70, v70
    v_exp_f32 v71, v71
    v_exp_f32 v72, v72
    v_cvt_pk_bf16_f32 v64, v64, v65
    v_cvt_pk_bf16_f32 v65, v66, v67
    v_cvt_pk_bf16_f32 v66, v68, v69
    v_cvt_pk_bf16_f32 v67, v70, v71
    v_exp_f32 v73, v73
    v_exp_f32 v74, v74
    v_mfma_f32_32x32x16_bf16 v[32:47], v[100:103], v[64:67], v[32:47]
    v_exp_f32 v75, v75
    v_exp_f32 v76, v76
    v_exp_f32 v77, v77
    v_exp_f32 v78, v78
    s_waitcnt vmcnt(9)
    v_mfma_f32_32x32x16_bf16 v[112:127], v[172:175], v[168:171], v[112:127]
    buffer_load_dwordx4 v[172:175], v7, s[28:31], s77 offen offset:2048
    v_exp_f32 v79, v79
    v_cvt_pk_bf16_f32 v72, v72, v73
    v_cvt_pk_bf16_f32 v73, v74, v75
    v_cvt_pk_bf16_f32 v74, v76, v77
    v_cvt_pk_bf16_f32 v75, v78, v79
    v_exp_f32 v80, v80
    v_exp_f32 v81, v81
    s_waitcnt lgkmcnt(0)
    v_mfma_f32_32x32x16_bf16 v[32:47], v[108:111], v[72:75], v[32:47]
    v_exp_f32 v82, v82
    v_exp_f32 v83, v83
    v_exp_f32 v84, v84
    v_exp_f32 v85, v85
    v_mfma_f32_32x32x16_bf16 v[64:79], v[96:99], v[8:11], v[16:31]
    v_exp_f32 v86, v86
    v_exp_f32 v87, v87
    v_exp_f32 v88, v88
    v_cvt_pk_bf16_f32 v80, v80, v81
    v_cvt_pk_bf16_f32 v81, v82, v83
    v_cvt_pk_bf16_f32 v82, v84, v85
    v_cvt_pk_bf16_f32 v83, v86, v87
    v_exp_f32 v89, v89
    v_exp_f32 v90, v90
    v_mfma_f32_32x32x16_bf16 v[48:63], v[100:103], v[80:83], v[48:63]
    v_exp_f32 v91, v91
    v_exp_f32 v92, v92
    v_exp_f32 v93, v93
    v_exp_f32 v94, v94
    v_mfma_f32_32x32x16_bf16 v[128:143], v[176:179], v[168:171], v[128:143]
    buffer_load_dwordx4 v[168:171], v7, s[28:31], s76 offen offset:2048 sc1
    buffer_load_dwordx4 v[176:179], v7, s[28:31], s78 offen offset:2048
    v_exp_f32 v95, v95
    v_cvt_pk_bf16_f32 v88, v88, v89
    v_cvt_pk_bf16_f32 v89, v90, v91
    v_cvt_pk_bf16_f32 v90, v92, v93
    v_cvt_pk_bf16_f32 v91, v94, v95
    v_exp_f32 v64, v64
    v_exp_f32 v65, v65
    v_mfma_f32_32x32x16_bf16 v[48:63], v[108:111], v[88:91], v[48:63]
    ds_read_b128 v[108:111], v6 offset:19872
    ds_read_b128 v[100:103], v5 offset:22080
    v_exp_f32 v66, v66
    v_exp_f32 v67, v67
    v_exp_f32 v68, v68
    v_exp_f32 v69, v69
    v_mfma_f32_32x32x16_bf16 v[80:95], v[96:99], v[12:15], v[16:31]
    ds_read_b128 v[96:99], v4 offset:20480
    v_exp_f32 v70, v70
    v_exp_f32 v71, v71
    v_exp_f32 v72, v72
    s_waitcnt vmcnt(9)
    v_mfma_f32_32x32x16_bf16 v[112:127], v[184:187], v[180:183], v[112:127]
    buffer_load_dwordx4 v[184:187], v7, s[28:31], s77 offen offset:3072
    v_cvt_pk_bf16_f32 v64, v64, v65
    v_cvt_pk_bf16_f32 v65, v66, v67
    v_cvt_pk_bf16_f32 v66, v68, v69
    v_cvt_pk_bf16_f32 v67, v70, v71
    v_exp_f32 v73, v73
    v_exp_f32 v74, v74
    v_mfma_f32_32x32x16_bf16 v[32:47], v[104:107], v[64:67], v[32:47]
    v_exp_f32 v75, v75
    v_exp_f32 v76, v76
    v_exp_f32 v77, v77
    v_exp_f32 v78, v78
    v_mfma_f32_32x32x16_bf16 v[128:143], v[188:191], v[180:183], v[128:143]
    buffer_load_dwordx4 v[180:183], v7, s[28:31], s76 offen offset:3072 sc1
    buffer_load_dwordx4 v[188:191], v7, s[28:31], s78 offen offset:3072
    v_exp_f32 v79, v79
    v_cvt_pk_bf16_f32 v72, v72, v73
    v_cvt_pk_bf16_f32 v73, v74, v75
    v_cvt_pk_bf16_f32 v74, v76, v77
    v_cvt_pk_bf16_f32 v75, v78, v79
    v_exp_f32 v80, v80
    v_exp_f32 v81, v81
    s_waitcnt lgkmcnt(0)
    v_mfma_f32_32x32x16_bf16 v[32:47], v[108:111], v[72:75], v[32:47]
    v_exp_f32 v82, v82
    v_exp_f32 v83, v83
    v_exp_f32 v84, v84
    v_exp_f32 v85, v85
    v_mfma_f32_32x32x16_bf16 v[64:79], v[96:99], v[8:11], v[16:31]
    v_exp_f32 v86, v86
    v_exp_f32 v87, v87
    v_exp_f32 v88, v88
    v_cvt_pk_bf16_f32 v80, v80, v81
    v_cvt_pk_bf16_f32 v81, v82, v83
    v_cvt_pk_bf16_f32 v82, v84, v85
    v_cvt_pk_bf16_f32 v83, v86, v87
    v_exp_f32 v89, v89
    v_exp_f32 v90, v90
    v_mfma_f32_32x32x16_bf16 v[48:63], v[104:107], v[80:83], v[48:63]
    v_exp_f32 v91, v91
    v_exp_f32 v92, v92
    v_exp_f32 v93, v93
    v_exp_f32 v94, v94
    v_add_u32 v7, 4096, v7
    s_waitcnt vmcnt(9)
    v_mfma_f32_32x32x16_bf16 v[112:127], v[148:151], v[144:147], v[112:127]
    buffer_load_dwordx4 v[148:151], v7, s[28:31], s77 offen offset:0
    v_exp_f32 v95, v95
    v_cvt_pk_bf16_f32 v88, v88, v89
    v_cvt_pk_bf16_f32 v89, v90, v91
    v_cvt_pk_bf16_f32 v90, v92, v93
    v_cvt_pk_bf16_f32 v91, v94, v95
    v_exp_f32 v64, v64
    v_exp_f32 v65, v65
    v_mfma_f32_32x32x16_bf16 v[48:63], v[108:111], v[88:91], v[48:63]
    ds_read_b128 v[108:111], v6 offset:22080
    ds_read_b128 v[104:107], v5 offset:24288
    v_exp_f32 v66, v66
    v_exp_f32 v67, v67
    v_exp_f32 v68, v68
    v_exp_f32 v69, v69
    v_mfma_f32_32x32x16_bf16 v[80:95], v[96:99], v[12:15], v[16:31]
    ds_read_b128 v[96:99], v4 offset:22528
    v_exp_f32 v70, v70
    v_exp_f32 v71, v71
    v_exp_f32 v72, v72
    v_cvt_pk_bf16_f32 v64, v64, v65
    v_cvt_pk_bf16_f32 v65, v66, v67
    v_cvt_pk_bf16_f32 v66, v68, v69
    v_cvt_pk_bf16_f32 v67, v70, v71
    v_exp_f32 v73, v73
    v_exp_f32 v74, v74
    v_mfma_f32_32x32x16_bf16 v[32:47], v[100:103], v[64:67], v[32:47]
    v_exp_f32 v75, v75
    v_exp_f32 v76, v76
    v_exp_f32 v77, v77
    v_exp_f32 v78, v78
    v_mfma_f32_32x32x16_bf16 v[128:143], v[152:155], v[144:147], v[128:143]
    buffer_load_dwordx4 v[144:147], v7, s[28:31], s76 offen offset:0 sc1
    buffer_load_dwordx4 v[152:155], v7, s[28:31], s78 offen offset:0
    v_exp_f32 v79, v79
    v_cvt_pk_bf16_f32 v72, v72, v73
    v_cvt_pk_bf16_f32 v73, v74, v75
    v_cvt_pk_bf16_f32 v74, v76, v77
    v_cvt_pk_bf16_f32 v75, v78, v79
    v_exp_f32 v80, v80
    v_exp_f32 v81, v81
    s_waitcnt lgkmcnt(0)
    v_mfma_f32_32x32x16_bf16 v[32:47], v[108:111], v[72:75], v[32:47]
    v_exp_f32 v82, v82
    v_exp_f32 v83, v83
    v_exp_f32 v84, v84
    v_exp_f32 v85, v85
    v_mfma_f32_32x32x16_bf16 v[64:79], v[96:99], v[8:11], v[16:31]
    v_exp_f32 v86, v86
    v_exp_f32 v87, v87
    v_exp_f32 v88, v88
    v_cvt_pk_bf16_f32 v80, v80, v81
    v_cvt_pk_bf16_f32 v81, v82, v83
    v_cvt_pk_bf16_f32 v82, v84, v85
    v_cvt_pk_bf16_f32 v83, v86, v87
    v_exp_f32 v89, v89
    v_exp_f32 v90, v90
    v_mfma_f32_32x32x16_bf16 v[48:63], v[100:103], v[80:83], v[48:63]
    v_exp_f32 v91, v91
    v_exp_f32 v92, v92
    v_exp_f32 v93, v93
    v_exp_f32 v94, v94
    s_waitcnt vmcnt(9)
    v_mfma_f32_32x32x16_bf16 v[112:127], v[160:163], v[156:159], v[112:127]
    buffer_load_dwordx4 v[160:163], v7, s[28:31], s77 offen offset:1024
    v_exp_f32 v95, v95
    v_cvt_pk_bf16_f32 v88, v88, v89
    v_cvt_pk_bf16_f32 v89, v90, v91
    v_cvt_pk_bf16_f32 v90, v92, v93
    v_cvt_pk_bf16_f32 v91, v94, v95
    s_setprio 1
    v_exp_f32 v64, v64
    v_exp_f32 v65, v65
    v_mfma_f32_32x32x16_bf16 v[48:63], v[108:111], v[88:91], v[48:63]
    ds_read_b128 v[108:111], v6 offset:24288
    ds_read_b128 v[100:103], v5 offset:26496
    v_exp_f32 v66, v66
    v_exp_f32 v67, v67
    v_exp_f32 v68, v68
    v_exp_f32 v69, v69
    v_mfma_f32_32x32x16_bf16 v[80:95], v[96:99], v[12:15], v[16:31]
    ds_read_b128 v[96:99], v4 offset:24576
    v_exp_f32 v70, v70
    v_exp_f32 v71, v71
    v_exp_f32 v72, v72
    v_cvt_pk_bf16_f32 v64, v64, v65
    v_cvt_pk_bf16_f32 v65, v66, v67
    v_cvt_pk_bf16_f32 v66, v68, v69
    v_cvt_pk_bf16_f32 v67, v70, v71
    v_exp_f32 v73, v73
    v_exp_f32 v74, v74
    v_mfma_f32_32x32x16_bf16 v[32:47], v[104:107], v[64:67], v[32:47]
    v_exp_f32 v75, v75
    v_exp_f32 v76, v76
    v_exp_f32 v77, v77
    v_exp_f32 v78, v78
    v_mfma_f32_32x32x16_bf16 v[128:143], v[164:167], v[156:159], v[128:143]
    buffer_load_dwordx4 v[156:159], v7, s[28:31], s76 offen offset:1024 sc1
    buffer_load_dwordx4 v[164:167], v7, s[28:31], s78 offen offset:1024
    v_exp_f32 v79, v79
    v_cvt_pk_bf16_f32 v72, v72, v73
    v_cvt_pk_bf16_f32 v73, v74, v75
    v_cvt_pk_bf16_f32 v74, v76, v77
    v_cvt_pk_bf16_f32 v75, v78, v79
    v_exp_f32 v80, v80
    v_exp_f32 v81, v81
    s_waitcnt lgkmcnt(0)
    v_mfma_f32_32x32x16_bf16 v[32:47], v[108:111], v[72:75], v[32:47]
    v_exp_f32 v82, v82
    v_exp_f32 v83, v83
    v_exp_f32 v84, v84
    v_exp_f32 v85, v85
    v_mfma_f32_32x32x16_bf16 v[64:79], v[96:99], v[8:11], v[16:31]
    v_exp_f32 v86, v86
    v_exp_f32 v87, v87
    v_exp_f32 v88, v88
    s_waitcnt vmcnt(9)
    v_mfma_f32_32x32x16_bf16 v[112:127], v[172:175], v[168:171], v[112:127]
    buffer_load_dwordx4 v[172:175], v7, s[28:31], s77 offen offset:2048
    v_cvt_pk_bf16_f32 v80, v80, v81
    v_cvt_pk_bf16_f32 v81, v82, v83
    v_cvt_pk_bf16_f32 v82, v84, v85
    v_cvt_pk_bf16_f32 v83, v86, v87
    v_exp_f32 v89, v89
    v_exp_f32 v90, v90
    v_mfma_f32_32x32x16_bf16 v[48:63], v[104:107], v[80:83], v[48:63]
    v_exp_f32 v91, v91
    v_exp_f32 v92, v92
    v_exp_f32 v93, v93
    v_exp_f32 v94, v94
    v_mfma_f32_32x32x16_bf16 v[128:143], v[176:179], v[168:171], v[128:143]
    buffer_load_dwordx4 v[168:171], v7, s[28:31], s76 offen offset:2048 sc1
    buffer_load_dwordx4 v[176:179], v7, s[28:31], s78 offen offset:2048
    v_exp_f32 v95, v95
    v_cvt_pk_bf16_f32 v88, v88, v89
    v_cvt_pk_bf16_f32 v89, v90, v91
    v_cvt_pk_bf16_f32 v90, v92, v93
    v_cvt_pk_bf16_f32 v91, v94, v95
    v_exp_f32 v64, v64
    v_exp_f32 v65, v65
    v_mfma_f32_32x32x16_bf16 v[48:63], v[108:111], v[88:91], v[48:63]
    ds_read_b128 v[108:111], v6 offset:26496
    ds_read_b128 v[104:107], v5 offset:28704
    v_exp_f32 v66, v66
    v_exp_f32 v67, v67
    v_exp_f32 v68, v68
    v_exp_f32 v69, v69
    v_mfma_f32_32x32x16_bf16 v[80:95], v[96:99], v[12:15], v[16:31]
    ds_read_b128 v[96:99], v4 offset:26624
    v_exp_f32 v70, v70
    v_exp_f32 v71, v71
    v_exp_f32 v72, v72
    v_cvt_pk_bf16_f32 v64, v64, v65
    v_cvt_pk_bf16_f32 v65, v66, v67
    v_cvt_pk_bf16_f32 v66, v68, v69
    v_cvt_pk_bf16_f32 v67, v70, v71
    v_exp_f32 v73, v73
    v_exp_f32 v74, v74
    v_mfma_f32_32x32x16_bf16 v[32:47], v[100:103], v[64:67], v[32:47]
    v_exp_f32 v75, v75
    v_exp_f32 v76, v76
    v_exp_f32 v77, v77
    v_exp_f32 v78, v78
    s_waitcnt vmcnt(9)
    v_mfma_f32_32x32x16_bf16 v[112:127], v[184:187], v[180:183], v[112:127]
    buffer_load_dwordx4 v[184:187], v7, s[28:31], s77 offen offset:3072
    v_exp_f32 v79, v79
    v_cvt_pk_bf16_f32 v72, v72, v73
    v_cvt_pk_bf16_f32 v73, v74, v75
    v_cvt_pk_bf16_f32 v74, v76, v77
    v_cvt_pk_bf16_f32 v75, v78, v79
    v_exp_f32 v80, v80
    v_exp_f32 v81, v81
    s_waitcnt lgkmcnt(0)
    v_mfma_f32_32x32x16_bf16 v[32:47], v[108:111], v[72:75], v[32:47]
    v_exp_f32 v82, v82
    v_exp_f32 v83, v83
    v_exp_f32 v84, v84
    v_exp_f32 v85, v85
    v_mfma_f32_32x32x16_bf16 v[64:79], v[96:99], v[8:11], v[16:31]
    v_exp_f32 v86, v86
    v_exp_f32 v87, v87
    v_exp_f32 v88, v88
    v_cvt_pk_bf16_f32 v80, v80, v81
    v_cvt_pk_bf16_f32 v81, v82, v83
    v_cvt_pk_bf16_f32 v82, v84, v85
    v_cvt_pk_bf16_f32 v83, v86, v87
    v_exp_f32 v89, v89
    v_exp_f32 v90, v90
    v_mfma_f32_32x32x16_bf16 v[48:63], v[100:103], v[80:83], v[48:63]
    v_exp_f32 v91, v91
    v_exp_f32 v92, v92
    v_exp_f32 v93, v93
    v_exp_f32 v94, v94
    v_mfma_f32_32x32x16_bf16 v[128:143], v[188:191], v[180:183], v[128:143]
    buffer_load_dwordx4 v[180:183], v7, s[28:31], s76 offen offset:3072 sc1
    buffer_load_dwordx4 v[188:191], v7, s[28:31], s78 offen offset:3072
    v_exp_f32 v95, v95
    v_cvt_pk_bf16_f32 v88, v88, v89
    v_cvt_pk_bf16_f32 v89, v90, v91
    v_cvt_pk_bf16_f32 v90, v92, v93
    v_cvt_pk_bf16_f32 v91, v94, v95
    v_exp_f32 v64, v64
    v_exp_f32 v65, v65
    v_mfma_f32_32x32x16_bf16 v[48:63], v[108:111], v[88:91], v[48:63]
    ds_read_b128 v[108:111], v6 offset:28704
    ds_read_b128 v[100:103], v5 offset:30912
    v_exp_f32 v66, v66
    v_exp_f32 v67, v67
    v_exp_f32 v68, v68
    v_exp_f32 v69, v69
    v_mfma_f32_32x32x16_bf16 v[80:95], v[96:99], v[12:15], v[16:31]
    ds_read_b128 v[96:99], v4 offset:28672
    v_exp_f32 v70, v70
    v_exp_f32 v71, v71
    v_exp_f32 v72, v72
    v_cvt_pk_bf16_f32 v64, v64, v65
    v_cvt_pk_bf16_f32 v65, v66, v67
    v_cvt_pk_bf16_f32 v66, v68, v69
    v_cvt_pk_bf16_f32 v67, v70, v71
    v_exp_f32 v73, v73
    v_exp_f32 v74, v74
    v_mfma_f32_32x32x16_bf16 v[32:47], v[104:107], v[64:67], v[32:47]
    v_exp_f32 v75, v75
    v_exp_f32 v76, v76
    v_exp_f32 v77, v77
    v_exp_f32 v78, v78
    v_add_u32 v7, 4096, v7
    s_waitcnt vmcnt(9)
    v_mfma_f32_32x32x16_bf16 v[112:127], v[148:151], v[144:147], v[112:127]
    buffer_load_dwordx4 v[148:151], v7, s[28:31], s77 offen offset:0
    v_exp_f32 v79, v79
    v_cvt_pk_bf16_f32 v72, v72, v73
    v_cvt_pk_bf16_f32 v73, v74, v75
    v_cvt_pk_bf16_f32 v74, v76, v77
    v_cvt_pk_bf16_f32 v75, v78, v79
    v_exp_f32 v80, v80
    v_exp_f32 v81, v81
    s_waitcnt lgkmcnt(0)
    v_mfma_f32_32x32x16_bf16 v[32:47], v[108:111], v[72:75], v[32:47]
    v_exp_f32 v82, v82
    v_exp_f32 v83, v83
    v_exp_f32 v84, v84
    v_exp_f32 v85, v85
    v_mfma_f32_32x32x16_bf16 v[64:79], v[96:99], v[8:11], v[16:31]
    v_exp_f32 v86, v86
    v_exp_f32 v87, v87
    v_exp_f32 v88, v88
    v_mfma_f32_32x32x16_bf16 v[128:143], v[152:155], v[144:147], v[128:143]
    buffer_load_dwordx4 v[144:147], v7, s[28:31], s76 offen offset:0 sc1
    buffer_load_dwordx4 v[152:155], v7, s[28:31], s78 offen offset:0
    v_cvt_pk_bf16_f32 v80, v80, v81
    v_cvt_pk_bf16_f32 v81, v82, v83
    v_cvt_pk_bf16_f32 v82, v84, v85
    v_cvt_pk_bf16_f32 v83, v86, v87
    v_exp_f32 v89, v89
    v_exp_f32 v90, v90
    v_mfma_f32_32x32x16_bf16 v[48:63], v[104:107], v[80:83], v[48:63]
    v_exp_f32 v91, v91
    v_exp_f32 v92, v92
    v_exp_f32 v93, v93
    v_exp_f32 v94, v94
    s_waitcnt vmcnt(9)
    v_mfma_f32_32x32x16_bf16 v[112:127], v[160:163], v[156:159], v[112:127]
    buffer_load_dwordx4 v[160:163], v7, s[28:31], s77 offen offset:1024
    v_exp_f32 v95, v95
    v_cvt_pk_bf16_f32 v88, v88, v89
    v_cvt_pk_bf16_f32 v89, v90, v91
    v_cvt_pk_bf16_f32 v90, v92, v93
    v_cvt_pk_bf16_f32 v91, v94, v95
    s_setprio 0
    v_exp_f32 v64, v64
    v_exp_f32 v65, v65
    v_mfma_f32_32x32x16_bf16 v[48:63], v[108:111], v[88:91], v[48:63]
    ds_read_b128 v[108:111], v6 offset:30912
    ds_read_b128 v[104:107], v5 offset:33120
    v_exp_f32 v66, v66
    v_exp_f32 v67, v67
    v_exp_f32 v68, v68
    v_exp_f32 v69, v69
    v_mfma_f32_32x32x16_bf16 v[80:95], v[96:99], v[12:15], v[16:31]
    ds_read_b128 v[96:99], v4 offset:30720
    v_exp_f32 v70, v70
    v_exp_f32 v71, v71
    v_exp_f32 v72, v72
    v_cvt_pk_bf16_f32 v64, v64, v65
    v_cvt_pk_bf16_f32 v65, v66, v67
    v_cvt_pk_bf16_f32 v66, v68, v69
    v_cvt_pk_bf16_f32 v67, v70, v71
    v_exp_f32 v73, v73
    v_exp_f32 v74, v74
    v_mfma_f32_32x32x16_bf16 v[32:47], v[100:103], v[64:67], v[32:47]
    v_exp_f32 v75, v75
    v_exp_f32 v76, v76
    v_exp_f32 v77, v77
    v_exp_f32 v78, v78
    v_mfma_f32_32x32x16_bf16 v[128:143], v[164:167], v[156:159], v[128:143]
    buffer_load_dwordx4 v[156:159], v7, s[28:31], s76 offen offset:1024 sc1
    buffer_load_dwordx4 v[164:167], v7, s[28:31], s78 offen offset:1024
    v_exp_f32 v79, v79
    v_cvt_pk_bf16_f32 v72, v72, v73
    v_cvt_pk_bf16_f32 v73, v74, v75
    v_cvt_pk_bf16_f32 v74, v76, v77
    v_cvt_pk_bf16_f32 v75, v78, v79
    v_exp_f32 v80, v80
    v_exp_f32 v81, v81
    s_waitcnt lgkmcnt(0)
    v_mfma_f32_32x32x16_bf16 v[32:47], v[108:111], v[72:75], v[32:47]
    v_exp_f32 v82, v82
    v_exp_f32 v83, v83
    v_exp_f32 v84, v84
    v_exp_f32 v85, v85
    v_mfma_f32_32x32x16_bf16 v[64:79], v[96:99], v[8:11], v[16:31]
    v_exp_f32 v86, v86
    v_exp_f32 v87, v87
    v_exp_f32 v88, v88
    v_cvt_pk_bf16_f32 v80, v80, v81
    v_cvt_pk_bf16_f32 v81, v82, v83
    v_cvt_pk_bf16_f32 v82, v84, v85
    v_cvt_pk_bf16_f32 v83, v86, v87
    v_exp_f32 v89, v89
    v_exp_f32 v90, v90
    v_mfma_f32_32x32x16_bf16 v[48:63], v[100:103], v[80:83], v[48:63]
    v_exp_f32 v91, v91
    v_exp_f32 v92, v92
    v_exp_f32 v93, v93
    v_exp_f32 v94, v94
    s_waitcnt vmcnt(9)
    v_mfma_f32_32x32x16_bf16 v[112:127], v[172:175], v[168:171], v[112:127]
    buffer_load_dwordx4 v[172:175], v7, s[28:31], s77 offen offset:2048
    v_exp_f32 v95, v95
    v_cvt_pk_bf16_f32 v88, v88, v89
    v_cvt_pk_bf16_f32 v89, v90, v91
    v_cvt_pk_bf16_f32 v90, v92, v93
    v_cvt_pk_bf16_f32 v91, v94, v95
    v_exp_f32 v64, v64
    v_exp_f32 v65, v65
    v_mfma_f32_32x32x16_bf16 v[48:63], v[108:111], v[88:91], v[48:63]
    ds_read_b128 v[108:111], v6 offset:33120
    v_exp_f32 v66, v66
    v_exp_f32 v67, v67
    v_exp_f32 v68, v68
    v_exp_f32 v69, v69
    v_mfma_f32_32x32x16_bf16 v[80:95], v[96:99], v[12:15], v[16:31]
    v_exp_f32 v70, v70
    v_exp_f32 v71, v71
    v_exp_f32 v72, v72
    v_cvt_pk_bf16_f32 v64, v64, v65
    v_cvt_pk_bf16_f32 v65, v66, v67
    v_cvt_pk_bf16_f32 v66, v68, v69
    v_cvt_pk_bf16_f32 v67, v70, v71
    v_exp_f32 v73, v73
    v_exp_f32 v74, v74
    v_mfma_f32_32x32x16_bf16 v[32:47], v[104:107], v[64:67], v[32:47]
    v_exp_f32 v75, v75
    v_exp_f32 v76, v76
    v_exp_f32 v77, v77
    v_exp_f32 v78, v78
    v_mfma_f32_32x32x16_bf16 v[128:143], v[176:179], v[168:171], v[128:143]
    buffer_load_dwordx4 v[168:171], v7, s[28:31], s76 offen offset:2048 sc1
    buffer_load_dwordx4 v[176:179], v7, s[28:31], s78 offen offset:2048
    v_exp_f32 v79, v79
    v_cvt_pk_bf16_f32 v72, v72, v73
    v_cvt_pk_bf16_f32 v73, v74, v75
    v_cvt_pk_bf16_f32 v74, v76, v77
    v_cvt_pk_bf16_f32 v75, v78, v79
    v_exp_f32 v80, v80
    v_exp_f32 v81, v81
    s_waitcnt lgkmcnt(0)
    v_mfma_f32_32x32x16_bf16 v[32:47], v[108:111], v[72:75], v[32:47]
    v_exp_f32 v82, v82
    v_exp_f32 v83, v83
    v_exp_f32 v84, v84
    v_exp_f32 v85, v85
    v_exp_f32 v86, v86
    v_exp_f32 v87, v87
    v_exp_f32 v88, v88
    v_add_u32 v96, s79, v3
    v_add_u32 v97, s80, v3
    v_lshl_add_u32 v98, v2, 2, s79
    v_lshl_add_u32 v99, v2, 2, s80
    v_mov_b32 v100, s82
    v_mov_b32 v101, s83
    v_and_b32 v102, 31, v2
    v_lshlrev_b32 v102, 2, v102
    s_waitcnt vmcnt(9)
    v_mfma_f32_32x32x16_bf16 v[112:127], v[184:187], v[180:183], v[112:127]
    buffer_load_dwordx4 v[184:187], v7, s[28:31], s77 offen offset:3072
    v_cvt_pk_bf16_f32 v80, v80, v81
    v_cvt_pk_bf16_f32 v81, v82, v83
    v_cvt_pk_bf16_f32 v82, v84, v85
    v_cvt_pk_bf16_f32 v83, v86, v87
    v_exp_f32 v89, v89
    v_exp_f32 v90, v90
    v_mfma_f32_32x32x16_bf16 v[48:63], v[104:107], v[80:83], v[48:63]
    v_exp_f32 v91, v91
    v_exp_f32 v92, v92
    v_exp_f32 v93, v93
    v_exp_f32 v94, v94
    s_cmp_eq_u32 s66, 0
    s_cbranch_scc1 L_x63
    ds_write_b128 v96, v[32:35]
    ds_write_b128 v96, v[36:39] offset:1024
    ds_write_b32 v98, v40 offset:2048
    ds_write_b32 v100, v100
L_x63:
    v_mfma_f32_32x32x16_bf16 v[128:143], v[188:191], v[180:183], v[128:143]
    buffer_load_dwordx4 v[180:183], v7, s[28:31], s76 offen offset:3072 sc1
    buffer_load_dwordx4 v[188:191], v7, s[28:31], s78 offen offset:3072
    v_exp_f32 v95, v95
    v_cvt_pk_bf16_f32 v88, v88, v89
    v_cvt_pk_bf16_f32 v89, v90, v91
    v_cvt_pk_bf16_f32 v90, v92, v93
    v_cvt_pk_bf16_f32 v91, v94, v95
    s_nop 1
    v_mfma_f32_32x32x16_bf16 v[48:63], v[108:111], v[88:91], v[48:63]
    buffer_load_dword v7, v102, s[28:31], s87 offen sc1
    s_cmp_lg_u32 s66, 0
    s_cbranch_scc1 L_sent
    s_nop 8
    ds_write_b128 v96, v[48:51]
    ds_write_b128 v96, v[52:55] offset:1024
    ds_write_b32 v98, v56 offset:2048
    ds_write_b32 v100, v100
L_sent:
    s_mov_b32 s98, 8388608
L_xw:
    ds_read_b32 v103, v101
    ds_read_b128 v[64:67], v97
    ds_read_b128 v[68:71], v97 offset:1024
    ds_read_b32 v72, v99 offset:2048
    s_waitcnt lgkmcnt(0)
    v_cmp_eq_u32 vcc, 0, v103
    s_nop 0
    s_cbranch_vccz L_xw_ok
    s_sleep 1
    s_sub_u32 s98, s98, 1
    s_cmp_lg_u32 s98, 0
    s_cbranch_scc1 L_xw
L_xw_ok:
    s_cmp_lg_u32 s66, 0
    s_cbranch_scc1 L_keepB
    v_add_f32 v32, v32, v64
    v_add_f32 v33, v33, v65
    v_add_f32 v34, v34, v66
    v_add_f32 v35, v35, v67
    v_add_f32 v36, v36, v68
    v_add_f32 v37, v37, v69
    v_add_f32 v38, v38, v70
    v_add_f32 v39, v39, v71
    v_add_f32 v40, v40, v72
    s_branch L_kept
L_keepB:
    v_add_f32 v32, v48, v64
    v_add_f32 v33, v49, v65
    v_add_f32 v34, v50, v66
    v_add_f32 v35, v51, v67
    v_add_f32 v36, v52, v68
    v_add_f32 v37, v53, v69
    v_add_f32 v38, v54, v70
    v_add_f32 v39, v55, v71
    v_add_f32 v40, v56, v72
L_kept:
    v_mov_b32 v48, v40
    s_nop 1
    v_permlane32_swap_b32 v40, v48
    v_cmp_nge_f32 vcc, 0x5d800000, v40
    s_nop 0
    s_mov_b64 s[82:83], vcc
    v_cmp_nle_f32 vcc, 0x21800000, v40
    s_nop 0
    s_or_b64 vcc, vcc, s[82:83]
    s_cbranch_vccnz L_redo
L_aok:
    v_rcp_f32 v12, v40
    s_nop 0
    v_mul_f32 v32, v12, v32
    v_mul_f32 v33, v12, v33
    v_mul_f32 v34, v12, v34
    v_mul_f32 v35, v12, v35
    v_mul_f32 v36, v12, v36
    v_mul_f32 v37, v12, v37
    v_mul_f32 v38, v12, v38
    v_mul_f32 v39, v12, v39
    v_cvt_pk_bf16_f32 v64, v32, v33
    v_cvt_pk_bf16_f32 v65, v34, v35
    v_cvt_pk_bf16_f32 v66, v36, v37
    v_cvt_pk_bf16_f32 v67, v38, v39
    v_min_u32 v64, -2, v64
    v_min_u32 v65, -2, v65
    v_min_u32 v66, -2, v66
    v_min_u32 v67, -2, v67
    buffer_store_dwordx4 v[64:67], v3, s[28:31], s81 offen sc1
    s_mov_b32 s32, s20
    s_mov_b32 s33, s21
    s_mov_b32 s34, 0x200000
    s_mov_b32 s35, 0x00020000
    s_lshl_b32 s79, s68, 15
    v_add_u32 v14, s79, v3
    s_lshl_b32 s80, s69, 13
    s_add_u32 s80, s80, s79
    v_add_u32 v15, s80, v3
    v_and_b32 v12, 31, v2
    v_lshlrev_b32 v12, 10, v12
    v_lshrrev_b32 v13, 5, v2
    v_lshl_or_b32 v11, v13, 4, v12
    s_lshl_b32 s79, s84, 15
    s_lshl_b32 s80, s64, 7
    s_add_u32 s79, s79, s80
    s_lshl_b32 s80, s69, 5
    s_add_u32 s79, s79, s80
    s_add_u32 s87, s85, 4096
    s_barrier
    s_waitcnt vmcnt(1)
    v_mfma_f32_32x32x16_bf16 v[112:127], v[148:151], v[144:147], v[112:127]
    v_mfma_f32_32x32x16_bf16 v[128:143], v[152:155], v[144:147], v[128:143]
    v_mfma_f32_32x32x16_bf16 v[112:127], v[160:163], v[156:159], v[112:127]
    v_mfma_f32_32x32x16_bf16 v[128:143], v[164:167], v[156:159], v[128:143]
    v_mfma_f32_32x32x16_bf16 v[112:127], v[172:175], v[168:171], v[112:127]
    v_mfma_f32_32x32x16_bf16 v[128:143], v[176:179], v[168:171], v[128:143]
    v_mfma_f32_32x32x16_bf16 v[112:127], v[184:187], v[180:183], v[112:127]
    v_mfma_f32_32x32x16_bf16 v[128:143], v[188:191], v[180:183], v[128:143]
    s_waitcnt vmcnt(0)
    buffer_load_dwordx4 v[16:19], v3, s[28:31], s85 offen offset:0 sc1
    buffer_load_dwordx4 v[20:23], v3, s[28:31], s85 offen offset:1024 sc1
    buffer_load_dwordx4 v[24:27], v3, s[28:31], s85 offen offset:2048 sc1
    buffer_load_dwordx4 v[28:31], v3, s[28:31], s85 offen offset:3072 sc1
    buffer_load_dwordx4 v[32:35], v3, s[28:31], s87 offen offset:0 sc1
    buffer_load_dwordx4 v[36:39], v3, s[28:31], s87 offen offset:1024 sc1
    buffer_load_dwordx4 v[40:43], v3, s[28:31], s87 offen offset:2048 sc1
    buffer_load_dwordx4 v[44:47], v3, s[28:31], s87 offen offset:3072 sc1
    v_sub_f32 v10, 1.0, v7
    s_nop 0
    v_mul_f32 v112, v10, v112
    v_mul_f32 v113, v10, v113
    v_mul_f32 v114, v10, v114
    v_mul_f32 v115, v10, v115
    v_mul_f32 v116, v10, v116
    v_mul_f32 v117, v10, v117
    v_mul_f32 v118, v10, v118
    v_mul_f32 v119, v10, v119
    v_mul_f32 v120, v10, v120
    v_mul_f32 v121, v10, v121
    v_mul_f32 v122, v10, v122
    v_mul_f32 v123, v10, v123
    v_mul_f32 v124, v10, v124
    v_mul_f32 v125, v10, v125
    v_mul_f32 v126, v10, v126
    v_mul_f32 v127, v10, v127
    v_mul_f32 v128, v10, v128
    v_mul_f32 v129, v10, v129
    v_mul_f32 v130, v10, v130
    v_mul_f32 v131, v10, v131
    v_mul_f32 v132, v10, v132
    v_mul_f32 v133, v10, v133
    v_mul_f32 v134, v10, v134
    v_mul_f32 v135, v10, v135
    v_mul_f32 v136, v10, v136
    v_mul_f32 v137, v10, v137
    v_mul_f32 v138, v10, v138
    v_mul_f32 v139, v10, v139
    v_mul_f32 v140, v10, v140
    v_mul_f32 v141, v10, v141
    v_mul_f32 v142, v10, v142
    v_mul_f32 v143, v10, v143
    s_mov_b32 s98, 1048576
    s_branch L_ps3c
    s_mov_b32 s98, 1048576
L_ps3:
    buffer_load_dwordx4 v[16:19], v3, s[28:31], s85 offen offset:0 sc1
    buffer_load_dwordx4 v[20:23], v3, s[28:31], s85 offen offset:1024 sc1
    buffer_load_dwordx4 v[24:27], v3, s[28:31], s85 offen offset:2048 sc1
    buffer_load_dwordx4 v[28:31], v3, s[28:31], s85 offen offset:3072 sc1
    buffer_load_dwordx4 v[32:35], v3, s[28:31], s87 offen offset:0 sc1
    buffer_load_dwordx4 v[36:39], v3, s[28:31], s87 offen offset:1024 sc1
    buffer_load_dwordx4 v[40:43], v3, s[28:31], s87 offen offset:2048 sc1
    buffer_load_dwordx4 v[44:47], v3, s[28:31], s87 offen offset:3072 sc1
L_ps3c:
    s_waitcnt vmcnt(7)
    v_mfma_f32_32x32x16_bf16 v[64:79], v[192:195], v[16:19], 0
    v_mfma_f32_32x32x16_bf16 v[80:95], v[224:227], v[16:19], 0
    v_max_u32 v12, v16, v17
    v_max3_u32 v12, v18, v19, v12
    s_waitcnt vmcnt(6)
    v_mfma_f32_32x32x16_bf16 v[64:79], v[196:199], v[20:23], v[64:79]
    v_mfma_f32_32x32x16_bf16 v[80:95], v[228:231], v[20:23], v[80:95]
    v_max3_u32 v12, v20, v21, v12
    v_max3_u32 v12, v22, v23, v12
    s_waitcnt vmcnt(5)
    v_mfma_f32_32x32x16_bf16 v[64:79], v[200:203], v[24:27], v[64:79]
    v_mfma_f32_32x32x16_bf16 v[80:95], v[232:235], v[24:27], v[80:95]
    v_max3_u32 v12, v24, v25, v12
    v_max3_u32 v12, v26, v27, v12
    s_waitcnt vmcnt(4)
    v_mfma_f32_32x32x16_bf16 v[64:79], v[204:207], v[28:31], v[64:79]
    v_mfma_f32_32x32x16_bf16 v[80:95], v[236:239], v[28:31], v[80:95]
    v_max3_u32 v12, v28, v29, v12
    v_max3_u32 v12, v30, v31, v12
    s_waitcnt vmcnt(3)
    v_mfma_f32_32x32x16_bf16 v[64:79], v[208:211], v[32:35], v[64:79]
    v_mfma_f32_32x32x16_bf16 v[80:95], v[240:243], v[32:35], v[80:95]
    v_max3_u32 v12, v32, v33, v12
    v_max3_u32 v12, v34, v35, v12
    s_waitcnt vmcnt(2)
    v_mfma_f32_32x32x16_bf16 v[64:79], v[212:215], v[36:39], v[64:79]
    v_mfma_f32_32x32x16_bf16 v[80:95], v[244:247], v[36:39], v[80:95]
    v_max3_u32 v12, v36, v37, v12
    v_max3_u32 v12, v38, v39, v12
    s_waitcnt vmcnt(1)
    v_mfma_f32_32x32x16_bf16 v[64:79], v[216:219], v[40:43], v[64:79]
    v_mfma_f32_32x32x16_bf16 v[80:95], v[248:251], v[40:43], v[80:95]
    v_max3_u32 v12, v40, v41, v12
    v_max3_u32 v12, v42, v43, v12
    s_waitcnt vmcnt(0)
    v_mfma_f32_32x32x16_bf16 v[64:79], v[220:223], v[44:47], v[64:79]
    v_mfma_f32_32x32x16_bf16 v[80:95], v[252:255], v[44:47], v[80:95]
    v_max3_u32 v12, v44, v45, v12
    v_max3_u32 v12, v46, v47, v12
    v_cmp_eq_u32 vcc, -1, v12
    s_nop 0
    s_cbranch_vccz L_ps3_ok
    s_sleep 4
    s_sub_u32 s98, s98, 1
    s_cmp_lg_u32 s98, 0
    s_cbranch_scc1 L_ps3
L_ps3_ok:
    s_cmp_lg_u32 s69, 0
    s_cbranch_scc1 L_red1
    s_nop 3
    v_fmac_f32 v120, v7, v72
    v_fmac_f32 v121, v7, v73
    v_fmac_f32 v122, v7, v74
    v_fmac_f32 v123, v7, v75
    v_fmac_f32 v124, v7, v76
    v_fmac_f32 v125, v7, v77
    v_fmac_f32 v126, v7, v78
    v_fmac_f32 v127, v7, v79
    ds_write_b128 v14, v[120:123] offset:12288
    ds_write_b128 v14, v[124:127] offset:13312
    v_fmac_f32 v128, v7, v80
    v_fmac_f32 v129, v7, v81
    v_fmac_f32 v130, v7, v82
    v_fmac_f32 v131, v7, v83
    v_fmac_f32 v132, v7, v84
    v_fmac_f32 v133, v7, v85
    v_fmac_f32 v134, v7, v86
    v_fmac_f32 v135, v7, v87
    ds_write_b128 v14, v[128:131] offset:18432
    ds_write_b128 v14, v[132:135] offset:19456
    v_fmac_f32 v136, v7, v88
    v_fmac_f32 v137, v7, v89
    v_fmac_f32 v138, v7, v90
    v_fmac_f32 v139, v7, v91
    v_fmac_f32 v140, v7, v92
    v_fmac_f32 v141, v7, v93
    v_fmac_f32 v142, v7, v94
    v_fmac_f32 v143, v7, v95
    ds_write_b128 v14, v[136:139] offset:24576
    ds_write_b128 v14, v[140:143] offset:25600
    v_fma_f32 v16, v7, v64, v112
    v_fma_f32 v17, v7, v65, v113
    v_fma_f32 v18, v7, v66, v114
    v_fma_f32 v19, v7, v67, v115
    v_fma_f32 v20, v7, v68, v116
    v_fma_f32 v21, v7, v69, v117
    v_fma_f32 v22, v7, v70, v118
    v_fma_f32 v23, v7, v71, v119
    s_branch L_redw
L_red1:
    s_cmp_lg_u32 s69, 1
    s_cbranch_scc1 L_red2
    s_nop 1
    v_fmac_f32 v112, v7, v64
    v_fmac_f32 v113, v7, v65
    v_fmac_f32 v114, v7, v66
    v_fmac_f32 v115, v7, v67
    v_fmac_f32 v116, v7, v68
    v_fmac_f32 v117, v7, v69
    v_fmac_f32 v118, v7, v70
    v_fmac_f32 v119, v7, v71
    ds_write_b128 v14, v[112:115] offset:0
    ds_write_b128 v14, v[116:119] offset:1024
    v_fmac_f32 v128, v7, v80
    v_fmac_f32 v129, v7, v81
    v_fmac_f32 v130, v7, v82
    v_fmac_f32 v131, v7, v83
    v_fmac_f32 v132, v7, v84
    v_fmac_f32 v133, v7, v85
    v_fmac_f32 v134, v7, v86
    v_fmac_f32 v135, v7, v87
    ds_write_b128 v14, v[128:131] offset:20480
    ds_write_b128 v14, v[132:135] offset:21504
    v_fmac_f32 v136, v7, v88
    v_fmac_f32 v137, v7, v89
    v_fmac_f32 v138, v7, v90
    v_fmac_f32 v139, v7, v91
    v_fmac_f32 v140, v7, v92
    v_fmac_f32 v141, v7, v93
    v_fmac_f32 v142, v7, v94
    v_fmac_f32 v143, v7, v95
    ds_write_b128 v14, v[136:139] offset:26624
    ds_write_b128 v14, v[140:143] offset:27648
    v_fma_f32 v16, v7, v72, v120
    v_fma_f32 v17, v7, v73, v121
    v_fma_f32 v18, v7, v74, v122
    v_fma_f32 v19, v7, v75, v123
    v_fma_f32 v20, v7, v76, v124
    v_fma_f32 v21, v7, v77, v125
    v_fma_f32 v22, v7, v78, v126
    v_fma_f32 v23, v7, v79, v127
    s_branch L_redw
L_red2:
    s_cmp_lg_u32 s69, 2
    s_cbranch_scc1 L_red3
    v_fmac_f32 v112, v7, v64
    v_fmac_f32 v113, v7, v65
    v_fmac_f32 v114, v7, v66
    v_fmac_f32 v115, v7, v67
    v_fmac_f32 v116, v7, v68
    v_fmac_f32 v117, v7, v69
    v_fmac_f32 v118, v7, v70
    v_fmac_f32 v119, v7, v71
    ds_write_b128 v14, v[112:115] offset:2048
    ds_write_b128 v14, v[116:119] offset:3072
    v_fmac_f32 v120, v7, v72
    v_fmac_f32 v121, v7, v73
    v_fmac_f32 v122, v7, v74
    v_fmac_f32 v123, v7, v75
    v_fmac_f32 v124, v7, v76
    v_fmac_f32 v125, v7, v77
    v_fmac_f32 v126, v7, v78
    v_fmac_f32 v127, v7, v79
    ds_write_b128 v14, v[120:123] offset:8192
    ds_write_b128 v14, v[124:127] offset:9216
    v_fmac_f32 v136, v7, v88
    v_fmac_f32 v137, v7, v89
    v_fmac_f32 v138, v7, v90
    v_fmac_f32 v139, v7, v91
    v_fmac_f32 v140, v7, v92
    v_fmac_f32 v141, v7, v93
    v_fmac_f32 v142, v7, v94
    v_fmac_f32 v143, v7, v95
    ds_write_b128 v14, v[136:139] offset:28672
    ds_write_b128 v14, v[140:143] offset:29696
    v_fma_f32 v16, v7, v80, v128
    v_fma_f32 v17, v7, v81, v129
    v_fma_f32 v18, v7, v82, v130
    v_fma_f32 v19, v7, v83, v131
    v_fma_f32 v20, v7, v84, v132
    v_fma_f32 v21, v7, v85, v133
    v_fma_f32 v22, v7, v86, v134
    v_fma_f32 v23, v7, v87, v135
    s_branch L_redw
L_red3:
    v_fmac_f32 v112, v7, v64
    v_fmac_f32 v113, v7, v65
    v_fmac_f32 v114, v7, v66
    v_fmac_f32 v115, v7, v67
    v_fmac_f32 v116, v7, v68
    v_fmac_f32 v117, v7, v69
    v_fmac_f32 v118, v7, v70
    v_fmac_f32 v119, v7, v71
    ds_write_b128 v14, v[112:115] offset:4096
    ds_write_b128 v14, v[116:119] offset:5120
    v_fmac_f32 v120, v7, v72
    v_fmac_f32 v121, v7, v73
    v_fmac_f32 v122, v7, v74
    v_fmac_f32 v123, v7, v75
    v_fmac_f32 v124, v7, v76
    v_fmac_f32 v125, v7, v77
    v_fmac_f32 v126, v7, v78
    v_fmac_f32 v127, v7, v79
    ds_write_b128 v14, v[120:123] offset:10240
    ds_write_b128 v14, v[124:127] offset:11264
    v_fmac_f32 v128, v7, v80
    v_fmac_f32 v129, v7, v81
    v_fmac_f32 v130, v7, v82
    v_fmac_f32 v131, v7, v83
    v_fmac_f32 v132, v7, v84
    v_fmac_f32 v133, v7, v85
    v_fmac_f32 v134, v7, v86
    v_fmac_f32 v135, v7, v87
    ds_write_b128 v14, v[128:131] offset:16384
    ds_write_b128 v14, v[132:135] offset:17408
    v_fma_f32 v16, v7, v88, v136
    v_fma_f32 v17, v7, v89, v137
    v_fma_f32 v18, v7, v90, v138
    v_fma_f32 v19, v7, v91, v139
    v_fma_f32 v20, v7, v92, v140
    v_fma_f32 v21, v7, v93, v141
    v_fma_f32 v22, v7, v94, v142
    v_fma_f32 v23, v7, v95, v143
L_redw:
    s_waitcnt lgkmcnt(0)
    s_barrier
    ds_read_b128 v[24:27], v15 offset:0
    ds_read_b128 v[28:31], v15 offset:1024
    ds_read_b128 v[32:35], v15 offset:2048
    ds_read_b128 v[36:39], v15 offset:3072
    ds_read_b128 v[40:43], v15 offset:4096
    ds_read_b128 v[44:47], v15 offset:5120
    s_waitcnt lgkmcnt(4)
    v_pk_add_f32 v[16:17], v[16:17], v[24:25]
    v_pk_add_f32 v[18:19], v[18:19], v[26:27]
    v_pk_add_f32 v[20:21], v[20:21], v[28:29]
    v_pk_add_f32 v[22:23], v[22:23], v[30:31]
    s_waitcnt lgkmcnt(0)
    v_pk_add_f32 v[32:33], v[32:33], v[40:41]
    v_pk_add_f32 v[34:35], v[34:35], v[42:43]
    v_pk_add_f32 v[36:37], v[36:37], v[44:45]
    v_pk_add_f32 v[38:39], v[38:39], v[46:47]
    v_pk_add_f32 v[16:17], v[16:17], v[32:33]
    v_pk_add_f32 v[18:19], v[18:19], v[34:35]
    v_pk_add_f32 v[20:21], v[20:21], v[36:37]
    v_pk_add_f32 v[22:23], v[22:23], v[38:39]
    v_cvt_pk_bf16_f32 v48, v16, v17
    v_cvt_pk_bf16_f32 v49, v18, v19
    v_cvt_pk_bf16_f32 v50, v20, v21
    v_cvt_pk_bf16_f32 v51, v22, v23
    s_nop 0
    v_permlane32_swap_b32 v48, v50
    v_permlane32_swap_b32 v49, v51
    buffer_store_dwordx4 v[48:51], v11, s[32:35], s79 offen
    s_endpgm
L_redo:
    s_cmp_eq_u32 s66, 0
    s_cbranch_scc1 L_redoA
    v_mov_b32 v8, v12
    v_mov_b32 v9, v13
    v_mov_b32 v10, v14
    v_mov_b32 v11, v15
L_redoA:
    s_mul_i32 s79, s66, 1104
    s_add_u32 s79, s79, 35328
    v_subrev_u32 v5, s79, v5
    v_subrev_u32 v6, s79, v6
    v_mov_b32 v4, v3
    v_mov_b32 v12, 0xff800000
    s_mov_b32 s80, 0
L_fmax:
    ds_read_b128 v[96:99], v4
    s_waitcnt lgkmcnt(0)
    v_mfma_f32_32x32x16_bf16 v[64:79], v[96:99], v[8:11], 0
    v_add_u32 v4, 1024, v4
    s_nop 10
    v_max3_f32 v12, v64, v65, v12
    v_max3_f32 v12, v66, v67, v12
    v_max3_f32 v12, v68, v69, v12
    v_max3_f32 v12, v70, v71, v12
    v_max3_f32 v12, v72, v73, v12
    v_max3_f32 v12, v74, v75, v12
    v_max3_f32 v12, v76, v77, v12
    v_max3_f32 v12, v78, v79, v12
    s_add_u32 s80, s80, 1
    s_cmp_lt_u32 s80, 64
    s_cbranch_scc1 L_fmax
    v_mov_b32 v13, v12
    s_nop 1
    v_permlane32_swap_b32 v13, v12
    v_max_f32 v12, v13, v12
    v_sub_f32 v16, 0, v12
    v_sub_f32 v17, 0, v12
    v_sub_f32 v18, 0, v12
    v_sub_f32 v19, 0, v12
    v_sub_f32 v20, 0, v12
    v_sub_f32 v21, 0, v12
    v_sub_f32 v22, 0, v12
    v_sub_f32 v23, 0, v12
    v_sub_f32 v24, 0, v12
    v_sub_f32 v25, 0, v12
    v_sub_f32 v26, 0, v12
    v_sub_f32 v27, 0, v12
    v_sub_f32 v28, 0, v12
    v_sub_f32 v29, 0, v12
    v_sub_f32 v30, 0, v12
    v_sub_f32 v31, 0, v12
    v_pk_mul_f32 v[32:33], 0, 0
    v_pk_mul_f32 v[34:35], 0, 0
    v_pk_mul_f32 v[36:37], 0, 0
    v_pk_mul_f32 v[38:39], 0, 0
    v_pk_mul_f32 v[40:41], 0, 0
    v_pk_mul_f32 v[42:43], 0, 0
    v_pk_mul_f32 v[44:45], 0, 0
    v_pk_mul_f32 v[46:47], 0, 0
    v_mov_b32 v4, v3
    s_mov_b32 s80, 0
L_fslow:
    ds_read_b128 v[96:99], v4
    ds_read_b128 v[100:103], v5
    ds_read_b128 v[108:111], v6
    s_waitcnt lgkmcnt(0)
    v_mfma_f32_32x32x16_bf16 v[64:79], v[96:99], v[8:11], v[16:31]
    v_add_u32 v4, 1024, v4
    v_add_u32 v5, 1104, v5
    v_add_u32 v6, 1104, v6
    s_nop 8
    v_exp_f32 v64, v64
    v_exp_f32 v65, v65
    v_exp_f32 v66, v66
    v_exp_f32 v67, v67
    v_exp_f32 v68, v68
    v_exp_f32 v69, v69
    v_exp_f32 v70, v70
    v_exp_f32 v71, v71
    v_exp_f32 v72, v72
    v_exp_f32 v73, v73
    v_exp_f32 v74, v74
    v_exp_f32 v75, v75
    v_exp_f32 v76, v76
    v_exp_f32 v77, v77
    v_exp_f32 v78, v78
    v_exp_f32 v79, v79
    v_cvt_pk_bf16_f32 v80, v64, v65
    v_cvt_pk_bf16_f32 v81, v66, v67
    v_cvt_pk_bf16_f32 v82, v68, v69
    v_cvt_pk_bf16_f32 v83, v70, v71
    v_cvt_pk_bf16_f32 v84, v72, v73
    v_cvt_pk_bf16_f32 v85, v74, v75
    v_cvt_pk_bf16_f32 v86, v76, v77
    v_cvt_pk_bf16_f32 v87, v78, v79
    v_mfma_f32_32x32x16_bf16 v[32:47], v[100:103], v[80:83], v[32:47]
    s_nop 0
    v_mfma_f32_32x32x16_bf16 v[32:47], v[108:111], v[84:87], v[32:47]
    s_add_u32 s80, s80, 1
    s_cmp_lt_u32 s80, 64
    s_cbranch_scc1 L_fslow
    s_nop 9
    v_mov_b32 v48, v40
    s_nop 1
    v_permlane32_swap_b32 v40, v48
    s_branch L_aok
L_exit:
    s_endpgm
.section .rodata,"a"
.p2align 6
.amdhsa_kernel gated_mix__mha_block__glu_gated_geglu__prompt_kernel
  .amdhsa_next_free_vgpr 256
  .amdhsa_next_free_sgpr 102
  .amdhsa_accum_offset 256
  .amdhsa_group_segment_fixed_size 0
  .amdhsa_kernarg_size 88
  .amdhsa_user_sgpr_count 2
  .amdhsa_user_sgpr_kernarg_segment_ptr 1
  .amdhsa_system_sgpr_workgroup_id_x 1
.end_amdhsa_kernel
```
